```python
import torch

def _softmax(x, axis=-1):
    return torch.softmax(x, dim=axis)
def _gelu(x):
    return torch.nn.functional.gelu(x, approximate="tanh")
def _silu(x):
    return torch.nn.functional.silu(x)
def _sigmoid(x):
    return torch.sigmoid(x)
def _layernorm(x, axis=-1, eps=1e-5):
    m = x.mean(dim=axis, keepdim=True)
    v = x.var(dim=axis, keepdim=True, unbiased=False)
    return (x - m) / torch.sqrt(v + eps)
def _scatter_add(tgt, idx, src, axis=0):
    return tgt.clone().index_add_(axis, idx, src)
def _segment_sum(src, seg, n):
    out = torch.zeros((n,) + src.shape[1:], dtype=src.dtype)
    return out.index_add_(0, seg, src)
def _pad(x, pw):
    flat = tuple(v for pair in reversed(pw) for v in pair)
    return torch.nn.functional.pad(x, flat)

kernel_name = 'recurrent_scan__mha_block_cached__glu_gated_geglu__prompt'

def setup_inputs():

    _w = (lambda a: (lambda t: t.to(torch.bfloat16) if t.is_floating_point() else t)(torch.as_tensor(a)))
    def _A_setup():
        B, Sq, D = 1, 2048, 512
        H, Sk, Dh = 32, 2048, 128
        return {
            "x": _w((lambda *s: torch.randn(*s, dtype=torch.bfloat16) * 0.05)(B, Sq, D)),
            "k_cache": _w((lambda *s: torch.randn(*s, dtype=torch.bfloat16) * 3.2)(B, H, Sk, Dh)),
            "v_cache": _w((lambda *s: torch.randn(*s, dtype=torch.bfloat16) * 3.2)(B, H, Sk, Dh)),
            "wq": _w((lambda *s: torch.randn(*s, dtype=torch.bfloat16) * 3.2)(D, H * Dh) * (D ** -0.5)),
            "wo": _w((lambda *s: torch.randn(*s, dtype=torch.bfloat16) * 3.2)(H * Dh, D) * ((H * Dh) ** -0.5)),
        }
    _A_in = _A_setup()

    def _B_setup():
        B, S, Dm, Df = 1, 2048, 512, 1792
        return {
            "x": _w((lambda *s: torch.randn(*s, dtype=torch.bfloat16) * 0.05)(B, S, Dm)),
            "w_gate": _w((lambda *s: torch.randn(*s, dtype=torch.bfloat16) * 0.4)(Dm, Df) * (Dm ** -0.5)),
            "w_up": _w((lambda *s: torch.randn(*s, dtype=torch.bfloat16) * 0.4)(Dm, Df) * (Dm ** -0.5)),
            "w_down": _w((lambda *s: torch.randn(*s, dtype=torch.bfloat16) * 0.4)(Df, Dm) * (Df ** -0.5)),
        }
    _B_in = _B_setup()

    return {
        "A_x": _A_in["x"],
        "A_k_cache": _A_in["k_cache"],
        "A_v_cache": _A_in["v_cache"],
        "A_wq": _A_in["wq"],
        "A_wo": _A_in["wo"],
        "B_x": _B_in["x"],
        "B_w_gate": _B_in["w_gate"],
        "B_w_up": _B_in["w_up"],
        "B_w_down": _B_in["w_down"],
    }

def reference(A_x, A_k_cache, A_v_cache, A_wq, A_wo, B_x, B_w_gate, B_w_up, B_w_down):
    def _A_ref(x, k_cache, v_cache, wq, wo):
        B, Sq, D = x.shape
        H, Dh = 32, 128
        q = (lambda x, *d: x.permute(*d))((x @ wq).reshape(B, Sq, H, Dh), 0, 2, 1, 3)
        scores = torch.einsum("bhqd,bhkd->bhqk", q, k_cache) * (Dh ** -0.5)
        p = _softmax(scores, axis=-1)
        o = torch.einsum("bhqk,bhkd->bhqd", p, v_cache)
        return (lambda x, *d: x.permute(*d))(o, 0, 2, 1, 3).reshape(B, Sq, H * Dh) @ wo

    def _B_ref(x, w_gate, w_up, w_down):
        g = torch.einsum("bsd,df->bsf", x, w_gate)
        u = torch.einsum("bsd,df->bsf", x, w_up)
        h = _gelu(g) * u
        return torch.einsum("bsf,fd->bsd", h, w_down)

    x = A_x
    xn = _layernorm(x, axis=-1)
    s = _A_ref(xn, A_k_cache, A_v_cache, A_wq, A_wo)
    g = _silu(_B_ref(xn, B_w_gate, B_w_up, B_w_down))
    return x + s * g
```

```asm
; @launch kernel=ln_kernel grid=(512,1,1) block=(256,1,1) lds=0
; @launch kernel=proj_kernel grid=(256,1,1) block=(512,1,1) lds=131072
; @launch kernel=attn_kernel grid=(256,1,1) block=(256,1,1) lds=131072
; @launch kernel=out_kernel grid=(256,1,1) block=(256,1,1) lds=163840
.amdgcn_target "amdgcn-amd-amdhsa--gfx950"
.text
.globl ln_kernel
.p2align 8
.type ln_kernel,@function
ln_kernel:
    s_cmp_ge_u32 s2, 512
    s_cbranch_scc1 ln_done
    s_load_dwordx2 s[4:5], s[0:1], 0
    s_load_dwordx2 s[6:7], s[0:1], 88
    v_lshrrev_b32 v1, 6, v0
    v_and_b32 v2, 63, v0
    s_lshl_b32 s3, s2, 2
    v_add_u32 v1, s3, v1
    v_lshlrev_b32 v3, 10, v1
    v_lshl_add_u32 v3, v2, 4, v3
    s_waitcnt lgkmcnt(0)
    s_mov_b32 s8, s4
    s_and_b32 s9, s5, 0xffff
    s_mov_b32 s10, 0x200000
    s_mov_b32 s11, 0x00020000
    s_mov_b32 s12, s6
    s_and_b32 s13, s7, 0xffff
    s_mov_b32 s14, 0x200000
    s_mov_b32 s15, 0x00020000
    buffer_load_dwordx4 v[4:7], v3, s[8:11], 0 offen
    s_waitcnt vmcnt(0)
    v_lshlrev_b32 v8, 16, v4
    v_and_b32 v9, 0xffff0000, v4
    v_lshlrev_b32 v10, 16, v5
    v_and_b32 v11, 0xffff0000, v5
    v_lshlrev_b32 v12, 16, v6
    v_and_b32 v13, 0xffff0000, v6
    v_lshlrev_b32 v14, 16, v7
    v_and_b32 v15, 0xffff0000, v7
    v_add_f32 v16, v8, v9
    v_add_f32 v16, v16, v10
    v_add_f32 v16, v16, v11
    v_add_f32 v16, v16, v12
    v_add_f32 v16, v16, v13
    v_add_f32 v16, v16, v14
    v_add_f32 v16, v16, v15
    ds_swizzle_b32 v17, v16 offset:0x041F
    s_waitcnt lgkmcnt(0)
    v_add_f32 v16, v16, v17
    ds_swizzle_b32 v17, v16 offset:0x081F
    s_waitcnt lgkmcnt(0)
    v_add_f32 v16, v16, v17
    ds_swizzle_b32 v17, v16 offset:0x101F
    s_waitcnt lgkmcnt(0)
    v_add_f32 v16, v16, v17
    ds_swizzle_b32 v17, v16 offset:0x201F
    s_waitcnt lgkmcnt(0)
    v_add_f32 v16, v16, v17
    ds_swizzle_b32 v17, v16 offset:0x401F
    s_waitcnt lgkmcnt(0)
    v_add_f32 v16, v16, v17
    v_mov_b32 v17, v16
    s_nop 1
    v_permlane32_swap_b32 v16, v17
    s_nop 1
    v_add_f32 v16, v16, v17
    v_mul_f32 v16, 0x3b000000, v16
    v_sub_f32 v18, v8, v16
    v_mul_f32 v19, v18, v18
    v_sub_f32 v18, v9, v16
    v_fmac_f32 v19, v18, v18
    v_sub_f32 v18, v10, v16
    v_fmac_f32 v19, v18, v18
    v_sub_f32 v18, v11, v16
    v_fmac_f32 v19, v18, v18
    v_sub_f32 v18, v12, v16
    v_fmac_f32 v19, v18, v18
    v_sub_f32 v18, v13, v16
    v_fmac_f32 v19, v18, v18
    v_sub_f32 v18, v14, v16
    v_fmac_f32 v19, v18, v18
    v_sub_f32 v18, v15, v16
    v_fmac_f32 v19, v18, v18
    ds_swizzle_b32 v17, v19 offset:0x041F
    s_waitcnt lgkmcnt(0)
    v_add_f32 v19, v19, v17
    ds_swizzle_b32 v17, v19 offset:0x081F
    s_waitcnt lgkmcnt(0)
    v_add_f32 v19, v19, v17
    ds_swizzle_b32 v17, v19 offset:0x101F
    s_waitcnt lgkmcnt(0)
    v_add_f32 v19, v19, v17
    ds_swizzle_b32 v17, v19 offset:0x201F
    s_waitcnt lgkmcnt(0)
    v_add_f32 v19, v19, v17
    ds_swizzle_b32 v17, v19 offset:0x401F
    s_waitcnt lgkmcnt(0)
    v_add_f32 v19, v19, v17
    v_mov_b32 v17, v19
    s_nop 1
    v_permlane32_swap_b32 v19, v17
    s_nop 1
    v_add_f32 v19, v19, v17
    v_mul_f32 v19, 0x3b000000, v19
    v_cvt_pk_bf16_f32 v16, v16, v16
    v_lshlrev_b32 v16, 16, v16
    v_cvt_pk_bf16_f32 v19, v19, v19
    v_lshlrev_b32 v19, 16, v19
    v_add_f32 v19, 0x3727c5ac, v19
    v_cvt_pk_bf16_f32 v19, v19, v19
    v_lshlrev_b32 v19, 16, v19
    v_sqrt_f32 v19, v19
    s_nop 0
    v_cvt_pk_bf16_f32 v19, v19, v19
    v_lshlrev_b32 v19, 16, v19
    v_rcp_f32 v20, v19
    s_nop 0
    v_sub_f32 v8, v8, v16
    v_cvt_pk_bf16_f32 v8, v8, v8
    v_lshlrev_b32 v8, 16, v8
    v_mul_f32 v21, v8, v20
    v_fma_f32 v22, -v21, v19, v8
    v_fma_f32 v8, v22, v20, v21
    v_sub_f32 v9, v9, v16
    v_cvt_pk_bf16_f32 v9, v9, v9
    v_lshlrev_b32 v9, 16, v9
    v_mul_f32 v21, v9, v20
    v_fma_f32 v22, -v21, v19, v9
    v_fma_f32 v9, v22, v20, v21
    v_sub_f32 v10, v10, v16
    v_cvt_pk_bf16_f32 v10, v10, v10
    v_lshlrev_b32 v10, 16, v10
    v_mul_f32 v21, v10, v20
    v_fma_f32 v22, -v21, v19, v10
    v_fma_f32 v10, v22, v20, v21
    v_sub_f32 v11, v11, v16
    v_cvt_pk_bf16_f32 v11, v11, v11
    v_lshlrev_b32 v11, 16, v11
    v_mul_f32 v21, v11, v20
    v_fma_f32 v22, -v21, v19, v11
    v_fma_f32 v11, v22, v20, v21
    v_sub_f32 v12, v12, v16
    v_cvt_pk_bf16_f32 v12, v12, v12
    v_lshlrev_b32 v12, 16, v12
    v_mul_f32 v21, v12, v20
    v_fma_f32 v22, -v21, v19, v12
    v_fma_f32 v12, v22, v20, v21
    v_sub_f32 v13, v13, v16
    v_cvt_pk_bf16_f32 v13, v13, v13
    v_lshlrev_b32 v13, 16, v13
    v_mul_f32 v21, v13, v20
    v_fma_f32 v22, -v21, v19, v13
    v_fma_f32 v13, v22, v20, v21
    v_sub_f32 v14, v14, v16
    v_cvt_pk_bf16_f32 v14, v14, v14
    v_lshlrev_b32 v14, 16, v14
    v_mul_f32 v21, v14, v20
    v_fma_f32 v22, -v21, v19, v14
    v_fma_f32 v14, v22, v20, v21
    v_sub_f32 v15, v15, v16
    v_cvt_pk_bf16_f32 v15, v15, v15
    v_lshlrev_b32 v15, 16, v15
    v_mul_f32 v21, v15, v20
    v_fma_f32 v22, -v21, v19, v15
    v_fma_f32 v15, v22, v20, v21
    v_cvt_pk_bf16_f32 v4, v8, v9
    v_cvt_pk_bf16_f32 v5, v10, v11
    v_cvt_pk_bf16_f32 v6, v12, v13
    v_cvt_pk_bf16_f32 v7, v14, v15
    v_lshrrev_b32 v20, 2, v2
    v_lshlrev_b32 v20, 17, v20
    v_lshl_add_u32 v20, v1, 6, v20
    v_and_b32 v21, 3, v2
    v_lshl_add_u32 v20, v21, 4, v20
    buffer_store_dwordx4 v[4:7], v20, s[12:15], 0 offen
ln_fin:
ln_done:
    s_endpgm
.globl proj_kernel
.p2align 8
.type proj_kernel,@function
proj_kernel:
    s_and_b32 s16, s2, 31
    s_lshr_b32 s17, s2, 5
    s_cmp_ge_u32 s17, 8
    s_cbranch_scc1 k1_done
    s_cmp_ge_u32 s16, 30
    s_cbranch_scc1 k1_relayout
    s_load_dwordx2 s[4:5], s[0:1], 24
    s_load_dwordx4 s[8:11], s[0:1], 48
    s_load_dwordx2 s[6:7], s[0:1], 88
    v_lshrrev_b32 v1, 6, v0
    v_and_b32 v0, 63, v0
    v_mov_b32 v108, v0
    s_nop 0
    v_readfirstlane_b32 s18, v1
    s_waitcnt lgkmcnt(0)
    s_mov_b32 s20, s6
    s_and_b32 s21, s7, 0xffff
    s_mov_b32 s22, 0x200000
    s_mov_b32 s23, 0x00020000
    s_lshr_b32 s37, s18, 2
    s_cmp_lt_u32 s16, 16
    s_cselect_b32 s35, 1, 0
    s_cbranch_scc0 k1_selgu
    s_lshl_b32 s38, s16, 9
    s_lshl_b32 s39, s37, 8
    s_add_u32 s38, s38, s39
    s_add_u32 s40, s4, s38
    s_addc_u32 s41, s5, 0
    s_mov_b32 s42, 8192
    s_mov_b32 s43, 0x400000
    s_sub_u32 s43, s43, s38
    s_branch k1_seldone
k1_selgu:
    s_sub_u32 s38, s16, 16
    s_lshl_b32 s38, s38, 8
    s_cmp_eq_u32 s37, 0
    s_cselect_b32 s40, s8, s10
    s_cselect_b32 s41, s9, s11
    s_add_u32 s40, s40, s38
    s_addc_u32 s41, s41, 0
    s_mov_b32 s42, 3584
    s_mov_b32 s43, 0x1c0000
    s_sub_u32 s43, s43, s38
k1_seldone:
    s_mov_b32 s24, s40
    s_and_b32 s25, s41, 0xffff
    s_mov_b32 s26, s43
    s_mov_b32 s27, 0x00020000
    s_lshl_b32 s30, s42, 5
    s_and_b32 s38, s18, 3
    s_lshl_b32 s39, s38, 3
    s_mul_i32 s29, s39, s42
    s_lshl_b32 s28, s17, 14
    s_lshl_b32 s39, s18, 11
    s_add_u32 s28, s28, s39
    s_lshl_b32 s31, s18, 11
    s_lshl_b32 s32, s37, 13
    s_lshl_b32 s39, s38, 11
    s_add_u32 s32, s32, s39
    s_add_u32 s32, s32, 16384
    v_lshrrev_b32 v1, 2, v0
    v_and_b32 v2, 3, v0
    v_lshrrev_b32 v3, 4, v0
    v_and_b32 v4, 3, v3
    v_xor_b32 v2, v2, v4
    v_lshlrev_b32 v2, 4, v2
    v_lshl_add_u32 v100, v1, 6, v2
    v_and_b32 v1, 15, v0
    v_lshlrev_b32 v4, 2, v3
    v_xor_b32 v1, v1, v4
    v_lshlrev_b32 v1, 4, v1
    v_mul_lo_u32 v4, v3, s42
    v_add_u32 v102, v1, v4
    s_lshl_b32 s39, s42, 2
    s_sub_u32 s39, s39, 1024
    v_add_u32 v103, s39, v102
    s_mov_b32 s33, 0
    s_add_u32 m0, s31, s33
    s_nop 0
    buffer_load_dwordx4 v100, s[20:23], s28 offen offset:0 lds
    buffer_load_dwordx4 v100, s[20:23], s28 offen offset:1024 lds
    s_add_u32 m0, s32, s33
    s_nop 0
    buffer_load_dwordx4 v102, s[24:27], s29 offen offset:0 lds
    buffer_load_dwordx4 v103, s[24:27], s29 offen offset:1024 lds
    s_add_u32 s28, s28, 0x20000
    s_add_u32 s29, s29, s30
    s_add_u32 s33, s33, 0x8000
    s_and_b32 s33, s33, 0x1ffff
    s_add_u32 m0, s31, s33
    s_nop 0
    buffer_load_dwordx4 v100, s[20:23], s28 offen offset:0 lds
    buffer_load_dwordx4 v100, s[20:23], s28 offen offset:1024 lds
    s_add_u32 m0, s32, s33
    s_nop 0
    buffer_load_dwordx4 v102, s[24:27], s29 offen offset:0 lds
    buffer_load_dwordx4 v103, s[24:27], s29 offen offset:1024 lds
    s_add_u32 s28, s28, 0x20000
    s_add_u32 s29, s29, s30
    s_add_u32 s33, s33, 0x8000
    s_and_b32 s33, s33, 0x1ffff
    s_add_u32 m0, s31, s33
    s_nop 0
    buffer_load_dwordx4 v100, s[20:23], s28 offen offset:0 lds
    buffer_load_dwordx4 v100, s[20:23], s28 offen offset:1024 lds
    s_add_u32 m0, s32, s33
    s_nop 0
    buffer_load_dwordx4 v102, s[24:27], s29 offen offset:0 lds
    buffer_load_dwordx4 v103, s[24:27], s29 offen offset:1024 lds
    s_add_u32 s28, s28, 0x20000
    s_add_u32 s29, s29, s30
    s_add_u32 s33, s33, 0x8000
    s_and_b32 s33, s33, 0x1ffff
    s_lshr_b32 s44, s18, 2
    s_and_b32 s45, s18, 3
    v_and_b32 v1, 31, v0
    v_lshrrev_b32 v2, 5, v0
    v_lshrrev_b32 v3, 2, v0
    v_and_b32 v3, 3, v3
    v_xor_b32 v4, v2, v3
    v_xor_b32 v5, 2, v4
    s_lshl_b32 s39, s44, 13
    v_lshlrev_b32 v1, 6, v1
    v_add_u32 v1, s39, v1
    v_lshl_add_u32 v104, v4, 4, v1
    v_lshl_add_u32 v105, v5, 4, v1
    v_lshrrev_b32 v1, 4, v0
    v_and_b32 v1, 1, v1
    v_and_b32 v3, 15, v0
    v_lshrrev_b32 v3, 2, v3
    v_and_b32 v4, 3, v0
    v_lshrrev_b32 v5, 1, v4
    v_lshl_add_u32 v5, v1, 1, v5
    s_lshl_b32 s39, s45, 2
    v_add_u32 v5, s39, v5
    v_lshlrev_b32 v6, 2, v3
    v_xor_b32 v7, v5, v6
    v_lshl_add_u32 v9, v2, 3, v3
    v_lshlrev_b32 v9, 8, v9
    v_and_b32 v4, 1, v4
    v_lshl_add_u32 v9, v4, 3, v9
    v_add_u32 v9, 0x4000, v9
    v_lshl_add_u32 v106, v7, 4, v9
    v_accvgpr_write_b32 a0, 0
    v_accvgpr_write_b32 a1, 0
    v_accvgpr_write_b32 a2, 0
    v_accvgpr_write_b32 a3, 0
    v_accvgpr_write_b32 a4, 0
    v_accvgpr_write_b32 a5, 0
    v_accvgpr_write_b32 a6, 0
    v_accvgpr_write_b32 a7, 0
    v_accvgpr_write_b32 a8, 0
    v_accvgpr_write_b32 a9, 0
    v_accvgpr_write_b32 a10, 0
    v_accvgpr_write_b32 a11, 0
    v_accvgpr_write_b32 a12, 0
    v_accvgpr_write_b32 a13, 0
    v_accvgpr_write_b32 a14, 0
    v_accvgpr_write_b32 a15, 0
    v_accvgpr_write_b32 a16, 0
    v_accvgpr_write_b32 a17, 0
    v_accvgpr_write_b32 a18, 0
    v_accvgpr_write_b32 a19, 0
    v_accvgpr_write_b32 a20, 0
    v_accvgpr_write_b32 a21, 0
    v_accvgpr_write_b32 a22, 0
    v_accvgpr_write_b32 a23, 0
    v_accvgpr_write_b32 a24, 0
    v_accvgpr_write_b32 a25, 0
    v_accvgpr_write_b32 a26, 0
    v_accvgpr_write_b32 a27, 0
    v_accvgpr_write_b32 a28, 0
    v_accvgpr_write_b32 a29, 0
    v_accvgpr_write_b32 a30, 0
    v_accvgpr_write_b32 a31, 0
    v_accvgpr_write_b32 a32, 0
    v_accvgpr_write_b32 a33, 0
    v_accvgpr_write_b32 a34, 0
    v_accvgpr_write_b32 a35, 0
    v_accvgpr_write_b32 a36, 0
    v_accvgpr_write_b32 a37, 0
    v_accvgpr_write_b32 a38, 0
    v_accvgpr_write_b32 a39, 0
    v_accvgpr_write_b32 a40, 0
    v_accvgpr_write_b32 a41, 0
    v_accvgpr_write_b32 a42, 0
    v_accvgpr_write_b32 a43, 0
    v_accvgpr_write_b32 a44, 0
    v_accvgpr_write_b32 a45, 0
    v_accvgpr_write_b32 a46, 0
    v_accvgpr_write_b32 a47, 0
    v_accvgpr_write_b32 a48, 0
    v_accvgpr_write_b32 a49, 0
    v_accvgpr_write_b32 a50, 0
    v_accvgpr_write_b32 a51, 0
    v_accvgpr_write_b32 a52, 0
    v_accvgpr_write_b32 a53, 0
    v_accvgpr_write_b32 a54, 0
    v_accvgpr_write_b32 a55, 0
    v_accvgpr_write_b32 a56, 0
    v_accvgpr_write_b32 a57, 0
    v_accvgpr_write_b32 a58, 0
    v_accvgpr_write_b32 a59, 0
    v_accvgpr_write_b32 a60, 0
    v_accvgpr_write_b32 a61, 0
    v_accvgpr_write_b32 a62, 0
    v_accvgpr_write_b32 a63, 0
    v_accvgpr_write_b32 a64, 0
    v_accvgpr_write_b32 a65, 0
    v_accvgpr_write_b32 a66, 0
    v_accvgpr_write_b32 a67, 0
    v_accvgpr_write_b32 a68, 0
    v_accvgpr_write_b32 a69, 0
    v_accvgpr_write_b32 a70, 0
    v_accvgpr_write_b32 a71, 0
    v_accvgpr_write_b32 a72, 0
    v_accvgpr_write_b32 a73, 0
    v_accvgpr_write_b32 a74, 0
    v_accvgpr_write_b32 a75, 0
    v_accvgpr_write_b32 a76, 0
    v_accvgpr_write_b32 a77, 0
    v_accvgpr_write_b32 a78, 0
    v_accvgpr_write_b32 a79, 0
    v_accvgpr_write_b32 a80, 0
    v_accvgpr_write_b32 a81, 0
    v_accvgpr_write_b32 a82, 0
    v_accvgpr_write_b32 a83, 0
    v_accvgpr_write_b32 a84, 0
    v_accvgpr_write_b32 a85, 0
    v_accvgpr_write_b32 a86, 0
    v_accvgpr_write_b32 a87, 0
    v_accvgpr_write_b32 a88, 0
    v_accvgpr_write_b32 a89, 0
    v_accvgpr_write_b32 a90, 0
    v_accvgpr_write_b32 a91, 0
    v_accvgpr_write_b32 a92, 0
    v_accvgpr_write_b32 a93, 0
    v_accvgpr_write_b32 a94, 0
    v_accvgpr_write_b32 a95, 0
    v_accvgpr_write_b32 a96, 0
    v_accvgpr_write_b32 a97, 0
    v_accvgpr_write_b32 a98, 0
    v_accvgpr_write_b32 a99, 0
    v_accvgpr_write_b32 a100, 0
    v_accvgpr_write_b32 a101, 0
    v_accvgpr_write_b32 a102, 0
    v_accvgpr_write_b32 a103, 0
    v_accvgpr_write_b32 a104, 0
    v_accvgpr_write_b32 a105, 0
    v_accvgpr_write_b32 a106, 0
    v_accvgpr_write_b32 a107, 0
    v_accvgpr_write_b32 a108, 0
    v_accvgpr_write_b32 a109, 0
    v_accvgpr_write_b32 a110, 0
    v_accvgpr_write_b32 a111, 0
    v_accvgpr_write_b32 a112, 0
    v_accvgpr_write_b32 a113, 0
    v_accvgpr_write_b32 a114, 0
    v_accvgpr_write_b32 a115, 0
    v_accvgpr_write_b32 a116, 0
    v_accvgpr_write_b32 a117, 0
    v_accvgpr_write_b32 a118, 0
    v_accvgpr_write_b32 a119, 0
    v_accvgpr_write_b32 a120, 0
    v_accvgpr_write_b32 a121, 0
    v_accvgpr_write_b32 a122, 0
    v_accvgpr_write_b32 a123, 0
    v_accvgpr_write_b32 a124, 0
    v_accvgpr_write_b32 a125, 0
    v_accvgpr_write_b32 a126, 0
    v_accvgpr_write_b32 a127, 0
    s_waitcnt vmcnt(4)
    s_barrier
    ds_read_b128 v[8:11], v104 offset:0
    ds_read_b64_tr_b16 v[0:1], v106 offset:0
    ds_read_b64_tr_b16 v[2:3], v106 offset:1024
    ds_read_b128 v[12:15], v104 offset:2048
    ds_read_b64_tr_b16 v[4:5], v106 offset:8192
    ds_read_b64_tr_b16 v[6:7], v106 offset:9216
    ds_read_b128 v[16:19], v104 offset:4096
    ds_read_b128 v[20:23], v104 offset:6144
    s_mov_b32 s34, 0
    s_mov_b32 s48, 0x8000
    s_mov_b32 s49, 0xfffe8000
    s_mov_b32 s46, 0
k1_loop:
    s_waitcnt lgkmcnt(0)
    v_mfma_f32_32x32x16_bf16 a[0:15], v[0:3], v[8:11], a[0:15]
    ds_read_b128 v[32:35], v105 offset:0
    ds_read_b64_tr_b16 v[24:25], v106 offset:4096
    ds_read_b64_tr_b16 v[26:27], v106 offset:5120
    v_mfma_f32_32x32x16_bf16 a[64:79], v[4:7], v[8:11], a[64:79]
    ds_read_b128 v[36:39], v105 offset:2048
    ds_read_b64_tr_b16 v[28:29], v106 offset:12288
    ds_read_b64_tr_b16 v[30:31], v106 offset:13312
    v_mfma_f32_32x32x16_bf16 a[16:31], v[0:3], v[12:15], a[16:31]
    ds_read_b128 v[40:43], v105 offset:4096
    ds_read_b128 v[44:47], v105 offset:6144
    s_add_u32 m0, s31, s33
    s_nop 0
    v_mfma_f32_32x32x16_bf16 a[80:95], v[4:7], v[12:15], a[80:95]
    buffer_load_dwordx4 v100, s[20:23], s28 offen offset:0 lds
    buffer_load_dwordx4 v100, s[20:23], s28 offen offset:1024 lds
    s_add_u32 m0, s32, s33
    s_nop 0
    v_mfma_f32_32x32x16_bf16 a[32:47], v[0:3], v[16:19], a[32:47]
    buffer_load_dwordx4 v102, s[24:27], s29 offen offset:0 lds
    buffer_load_dwordx4 v103, s[24:27], s29 offen offset:1024 lds
    s_add_u32 s28, s28, 0x20000
    v_mfma_f32_32x32x16_bf16 a[96:111], v[4:7], v[16:19], a[96:111]
    s_add_u32 s29, s29, s30
    s_add_u32 s33, s33, 0x8000
    s_and_b32 s33, s33, 0x1ffff
    v_mfma_f32_32x32x16_bf16 a[48:63], v[0:3], v[20:23], a[48:63]
    v_mfma_f32_32x32x16_bf16 a[112:127], v[4:7], v[20:23], a[112:127]
    s_waitcnt lgkmcnt(0)
    v_mfma_f32_32x32x16_bf16 a[0:15], v[24:27], v[32:35], a[0:15]
    s_add_u32 s46, s46, 1
    s_and_b32 s46, s46, 3
    s_cmp_eq_u32 s46, 0
    v_mfma_f32_32x32x16_bf16 a[64:79], v[28:31], v[32:35], a[64:79]
    s_cselect_b32 s36, s49, s48
    v_add_u32 v104, s36, v104
    v_add_u32 v105, s36, v105
    v_mfma_f32_32x32x16_bf16 a[16:31], v[24:27], v[36:39], a[16:31]
    v_add_u32 v106, s36, v106
    ds_read_b128 v[8:11], v104 offset:0
    ds_read_b64_tr_b16 v[0:1], v106 offset:0
    v_mfma_f32_32x32x16_bf16 a[80:95], v[28:31], v[36:39], a[80:95]
    ds_read_b64_tr_b16 v[2:3], v106 offset:1024
    ds_read_b128 v[12:15], v104 offset:2048
    ds_read_b64_tr_b16 v[4:5], v106 offset:8192
    v_mfma_f32_32x32x16_bf16 a[32:47], v[24:27], v[40:43], a[32:47]
    ds_read_b64_tr_b16 v[6:7], v106 offset:9216
    ds_read_b128 v[16:19], v104 offset:4096
    ds_read_b128 v[20:23], v104 offset:6144
    v_mfma_f32_32x32x16_bf16 a[96:111], v[28:31], v[40:43], a[96:111]
    v_mfma_f32_32x32x16_bf16 a[48:63], v[24:27], v[44:47], a[48:63]
    v_mfma_f32_32x32x16_bf16 a[112:127], v[28:31], v[44:47], a[112:127]
    s_waitcnt vmcnt(4)
    s_barrier
    s_add_u32 s34, s34, 1
    s_cmp_lt_u32 s34, 16
    s_cbranch_scc1 k1_loop
    s_waitcnt vmcnt(0) lgkmcnt(0)
    s_nop 15
    s_nop 7
    v_mov_b32 v0, v108
    v_and_b32 v1, 31, v0
    v_lshrrev_b32 v2, 5, v0
    s_lshl_b32 s38, s17, 8
    s_lshl_b32 s39, s44, 7
    s_add_u32 s38, s38, s39
    v_add_u32 v1, s38, v1
    v_lshlrev_b32 v3, 8, v1
    v_lshl_add_u32 v3, v2, 4, v3
    s_lshl_b32 s39, s45, 6
    v_add_u32 v3, s39, v3
    s_cmp_eq_u32 s35, 0
    s_cbranch_scc1 k1_epi_gu
    s_add_u32 s40, s6, 0x400000
    s_addc_u32 s41, s7, 0
    s_mov_b32 s24, s40
    s_and_b32 s25, s41, 0xffff
    s_mov_b32 s26, 0x1000000
    s_mov_b32 s27, 0x00020000
    s_lshl_b32 s38, s16, 20
    v_add_u32 v3, s38, v3
    v_add_u32 v4, 0x80000, v3
    v_accvgpr_read_b32 v8, a0
    v_accvgpr_read_b32 v9, a1
    v_accvgpr_read_b32 v10, a2
    v_accvgpr_read_b32 v11, a3
    v_accvgpr_read_b32 v12, a4
    v_accvgpr_read_b32 v13, a5
    v_accvgpr_read_b32 v14, a6
    v_accvgpr_read_b32 v15, a7
    v_accvgpr_read_b32 v16, a8
    v_accvgpr_read_b32 v17, a9
    v_accvgpr_read_b32 v18, a10
    v_accvgpr_read_b32 v19, a11
    v_accvgpr_read_b32 v20, a12
    v_accvgpr_read_b32 v21, a13
    v_accvgpr_read_b32 v22, a14
    v_accvgpr_read_b32 v23, a15
    v_mul_f32 v8, 0x3e0293ee, v8
    v_mul_f32 v9, 0x3e0293ee, v9
    v_mul_f32 v10, 0x3e0293ee, v10
    v_mul_f32 v11, 0x3e0293ee, v11
    v_mul_f32 v12, 0x3e0293ee, v12
    v_mul_f32 v13, 0x3e0293ee, v13
    v_mul_f32 v14, 0x3e0293ee, v14
    v_mul_f32 v15, 0x3e0293ee, v15
    v_mul_f32 v16, 0x3e0293ee, v16
    v_mul_f32 v17, 0x3e0293ee, v17
    v_mul_f32 v18, 0x3e0293ee, v18
    v_mul_f32 v19, 0x3e0293ee, v19
    v_mul_f32 v20, 0x3e0293ee, v20
    v_mul_f32 v21, 0x3e0293ee, v21
    v_mul_f32 v22, 0x3e0293ee, v22
    v_mul_f32 v23, 0x3e0293ee, v23
    v_cvt_pk_bf16_f32 v24, v8, v9
    v_cvt_pk_bf16_f32 v25, v10, v11
    v_cvt_pk_bf16_f32 v26, v12, v13
    v_cvt_pk_bf16_f32 v27, v14, v15
    v_cvt_pk_bf16_f32 v28, v16, v17
    v_cvt_pk_bf16_f32 v29, v18, v19
    v_cvt_pk_bf16_f32 v30, v20, v21
    v_cvt_pk_bf16_f32 v31, v22, v23
    s_nop 1
    v_permlane32_swap_b32 v24, v26
    v_permlane32_swap_b32 v25, v27
    buffer_store_dwordx4 v[24:27], v3, s[24:27], 0 offen offset:0
    v_permlane32_swap_b32 v28, v30
    v_permlane32_swap_b32 v29, v31
    buffer_store_dwordx4 v[28:31], v3, s[24:27], 0 offen offset:32
    s_nop 1
    v_accvgpr_read_b32 v8, a64
    v_accvgpr_read_b32 v9, a65
    v_accvgpr_read_b32 v10, a66
    v_accvgpr_read_b32 v11, a67
    v_accvgpr_read_b32 v12, a68
    v_accvgpr_read_b32 v13, a69
    v_accvgpr_read_b32 v14, a70
    v_accvgpr_read_b32 v15, a71
    v_accvgpr_read_b32 v16, a72
    v_accvgpr_read_b32 v17, a73
    v_accvgpr_read_b32 v18, a74
    v_accvgpr_read_b32 v19, a75
    v_accvgpr_read_b32 v20, a76
    v_accvgpr_read_b32 v21, a77
    v_accvgpr_read_b32 v22, a78
    v_accvgpr_read_b32 v23, a79
    v_mul_f32 v8, 0x3e0293ee, v8
    v_mul_f32 v9, 0x3e0293ee, v9
    v_mul_f32 v10, 0x3e0293ee, v10
    v_mul_f32 v11, 0x3e0293ee, v11
    v_mul_f32 v12, 0x3e0293ee, v12
    v_mul_f32 v13, 0x3e0293ee, v13
    v_mul_f32 v14, 0x3e0293ee, v14
    v_mul_f32 v15, 0x3e0293ee, v15
    v_mul_f32 v16, 0x3e0293ee, v16
    v_mul_f32 v17, 0x3e0293ee, v17
    v_mul_f32 v18, 0x3e0293ee, v18
    v_mul_f32 v19, 0x3e0293ee, v19
    v_mul_f32 v20, 0x3e0293ee, v20
    v_mul_f32 v21, 0x3e0293ee, v21
    v_mul_f32 v22, 0x3e0293ee, v22
    v_mul_f32 v23, 0x3e0293ee, v23
    v_cvt_pk_bf16_f32 v24, v8, v9
    v_cvt_pk_bf16_f32 v25, v10, v11
    v_cvt_pk_bf16_f32 v26, v12, v13
    v_cvt_pk_bf16_f32 v27, v14, v15
    v_cvt_pk_bf16_f32 v28, v16, v17
    v_cvt_pk_bf16_f32 v29, v18, v19
    v_cvt_pk_bf16_f32 v30, v20, v21
    v_cvt_pk_bf16_f32 v31, v22, v23
    s_nop 1
    v_permlane32_swap_b32 v24, v26
    v_permlane32_swap_b32 v25, v27
    buffer_store_dwordx4 v[24:27], v4, s[24:27], 0 offen offset:0
    v_permlane32_swap_b32 v28, v30
    v_permlane32_swap_b32 v29, v31
    buffer_store_dwordx4 v[28:31], v4, s[24:27], 0 offen offset:32
    s_nop 1
    v_add_u32 v3, 0x2000, v3
    v_add_u32 v4, 0x2000, v4
    v_accvgpr_read_b32 v8, a16
    v_accvgpr_read_b32 v9, a17
    v_accvgpr_read_b32 v10, a18
    v_accvgpr_read_b32 v11, a19
    v_accvgpr_read_b32 v12, a20
    v_accvgpr_read_b32 v13, a21
    v_accvgpr_read_b32 v14, a22
    v_accvgpr_read_b32 v15, a23
    v_accvgpr_read_b32 v16, a24
    v_accvgpr_read_b32 v17, a25
    v_accvgpr_read_b32 v18, a26
    v_accvgpr_read_b32 v19, a27
    v_accvgpr_read_b32 v20, a28
    v_accvgpr_read_b32 v21, a29
    v_accvgpr_read_b32 v22, a30
    v_accvgpr_read_b32 v23, a31
    v_mul_f32 v8, 0x3e0293ee, v8
    v_mul_f32 v9, 0x3e0293ee, v9
    v_mul_f32 v10, 0x3e0293ee, v10
    v_mul_f32 v11, 0x3e0293ee, v11
    v_mul_f32 v12, 0x3e0293ee, v12
    v_mul_f32 v13, 0x3e0293ee, v13
    v_mul_f32 v14, 0x3e0293ee, v14
    v_mul_f32 v15, 0x3e0293ee, v15
    v_mul_f32 v16, 0x3e0293ee, v16
    v_mul_f32 v17, 0x3e0293ee, v17
    v_mul_f32 v18, 0x3e0293ee, v18
    v_mul_f32 v19, 0x3e0293ee, v19
    v_mul_f32 v20, 0x3e0293ee, v20
    v_mul_f32 v21, 0x3e0293ee, v21
    v_mul_f32 v22, 0x3e0293ee, v22
    v_mul_f32 v23, 0x3e0293ee, v23
    v_cvt_pk_bf16_f32 v24, v8, v9
    v_cvt_pk_bf16_f32 v25, v10, v11
    v_cvt_pk_bf16_f32 v26, v12, v13
    v_cvt_pk_bf16_f32 v27, v14, v15
    v_cvt_pk_bf16_f32 v28, v16, v17
    v_cvt_pk_bf16_f32 v29, v18, v19
    v_cvt_pk_bf16_f32 v30, v20, v21
    v_cvt_pk_bf16_f32 v31, v22, v23
    s_nop 1
    v_permlane32_swap_b32 v24, v26
    v_permlane32_swap_b32 v25, v27
    buffer_store_dwordx4 v[24:27], v3, s[24:27], 0 offen offset:0
    v_permlane32_swap_b32 v28, v30
    v_permlane32_swap_b32 v29, v31
    buffer_store_dwordx4 v[28:31], v3, s[24:27], 0 offen offset:32
    s_nop 1
    v_accvgpr_read_b32 v8, a80
    v_accvgpr_read_b32 v9, a81
    v_accvgpr_read_b32 v10, a82
    v_accvgpr_read_b32 v11, a83
    v_accvgpr_read_b32 v12, a84
    v_accvgpr_read_b32 v13, a85
    v_accvgpr_read_b32 v14, a86
    v_accvgpr_read_b32 v15, a87
    v_accvgpr_read_b32 v16, a88
    v_accvgpr_read_b32 v17, a89
    v_accvgpr_read_b32 v18, a90
    v_accvgpr_read_b32 v19, a91
    v_accvgpr_read_b32 v20, a92
    v_accvgpr_read_b32 v21, a93
    v_accvgpr_read_b32 v22, a94
    v_accvgpr_read_b32 v23, a95
    v_mul_f32 v8, 0x3e0293ee, v8
    v_mul_f32 v9, 0x3e0293ee, v9
    v_mul_f32 v10, 0x3e0293ee, v10
    v_mul_f32 v11, 0x3e0293ee, v11
    v_mul_f32 v12, 0x3e0293ee, v12
    v_mul_f32 v13, 0x3e0293ee, v13
    v_mul_f32 v14, 0x3e0293ee, v14
    v_mul_f32 v15, 0x3e0293ee, v15
    v_mul_f32 v16, 0x3e0293ee, v16
    v_mul_f32 v17, 0x3e0293ee, v17
    v_mul_f32 v18, 0x3e0293ee, v18
    v_mul_f32 v19, 0x3e0293ee, v19
    v_mul_f32 v20, 0x3e0293ee, v20
    v_mul_f32 v21, 0x3e0293ee, v21
    v_mul_f32 v22, 0x3e0293ee, v22
    v_mul_f32 v23, 0x3e0293ee, v23
    v_cvt_pk_bf16_f32 v24, v8, v9
    v_cvt_pk_bf16_f32 v25, v10, v11
    v_cvt_pk_bf16_f32 v26, v12, v13
    v_cvt_pk_bf16_f32 v27, v14, v15
    v_cvt_pk_bf16_f32 v28, v16, v17
    v_cvt_pk_bf16_f32 v29, v18, v19
    v_cvt_pk_bf16_f32 v30, v20, v21
    v_cvt_pk_bf16_f32 v31, v22, v23
    s_nop 1
    v_permlane32_swap_b32 v24, v26
    v_permlane32_swap_b32 v25, v27
    buffer_store_dwordx4 v[24:27], v4, s[24:27], 0 offen offset:0
    v_permlane32_swap_b32 v28, v30
    v_permlane32_swap_b32 v29, v31
    buffer_store_dwordx4 v[28:31], v4, s[24:27], 0 offen offset:32
    s_nop 1
    v_add_u32 v3, 0x2000, v3
    v_add_u32 v4, 0x2000, v4
    v_accvgpr_read_b32 v8, a32
    v_accvgpr_read_b32 v9, a33
    v_accvgpr_read_b32 v10, a34
    v_accvgpr_read_b32 v11, a35
    v_accvgpr_read_b32 v12, a36
    v_accvgpr_read_b32 v13, a37
    v_accvgpr_read_b32 v14, a38
    v_accvgpr_read_b32 v15, a39
    v_accvgpr_read_b32 v16, a40
    v_accvgpr_read_b32 v17, a41
    v_accvgpr_read_b32 v18, a42
    v_accvgpr_read_b32 v19, a43
    v_accvgpr_read_b32 v20, a44
    v_accvgpr_read_b32 v21, a45
    v_accvgpr_read_b32 v22, a46
    v_accvgpr_read_b32 v23, a47
    v_mul_f32 v8, 0x3e0293ee, v8
    v_mul_f32 v9, 0x3e0293ee, v9
    v_mul_f32 v10, 0x3e0293ee, v10
    v_mul_f32 v11, 0x3e0293ee, v11
    v_mul_f32 v12, 0x3e0293ee, v12
    v_mul_f32 v13, 0x3e0293ee, v13
    v_mul_f32 v14, 0x3e0293ee, v14
    v_mul_f32 v15, 0x3e0293ee, v15
    v_mul_f32 v16, 0x3e0293ee, v16
    v_mul_f32 v17, 0x3e0293ee, v17
    v_mul_f32 v18, 0x3e0293ee, v18
    v_mul_f32 v19, 0x3e0293ee, v19
    v_mul_f32 v20, 0x3e0293ee, v20
    v_mul_f32 v21, 0x3e0293ee, v21
    v_mul_f32 v22, 0x3e0293ee, v22
    v_mul_f32 v23, 0x3e0293ee, v23
    v_cvt_pk_bf16_f32 v24, v8, v9
    v_cvt_pk_bf16_f32 v25, v10, v11
    v_cvt_pk_bf16_f32 v26, v12, v13
    v_cvt_pk_bf16_f32 v27, v14, v15
    v_cvt_pk_bf16_f32 v28, v16, v17
    v_cvt_pk_bf16_f32 v29, v18, v19
    v_cvt_pk_bf16_f32 v30, v20, v21
    v_cvt_pk_bf16_f32 v31, v22, v23
    s_nop 1
    v_permlane32_swap_b32 v24, v26
    v_permlane32_swap_b32 v25, v27
    buffer_store_dwordx4 v[24:27], v3, s[24:27], 0 offen offset:0
    v_permlane32_swap_b32 v28, v30
    v_permlane32_swap_b32 v29, v31
    buffer_store_dwordx4 v[28:31], v3, s[24:27], 0 offen offset:32
    s_nop 1
    v_accvgpr_read_b32 v8, a96
    v_accvgpr_read_b32 v9, a97
    v_accvgpr_read_b32 v10, a98
    v_accvgpr_read_b32 v11, a99
    v_accvgpr_read_b32 v12, a100
    v_accvgpr_read_b32 v13, a101
    v_accvgpr_read_b32 v14, a102
    v_accvgpr_read_b32 v15, a103
    v_accvgpr_read_b32 v16, a104
    v_accvgpr_read_b32 v17, a105
    v_accvgpr_read_b32 v18, a106
    v_accvgpr_read_b32 v19, a107
    v_accvgpr_read_b32 v20, a108
    v_accvgpr_read_b32 v21, a109
    v_accvgpr_read_b32 v22, a110
    v_accvgpr_read_b32 v23, a111
    v_mul_f32 v8, 0x3e0293ee, v8
    v_mul_f32 v9, 0x3e0293ee, v9
    v_mul_f32 v10, 0x3e0293ee, v10
    v_mul_f32 v11, 0x3e0293ee, v11
    v_mul_f32 v12, 0x3e0293ee, v12
    v_mul_f32 v13, 0x3e0293ee, v13
    v_mul_f32 v14, 0x3e0293ee, v14
    v_mul_f32 v15, 0x3e0293ee, v15
    v_mul_f32 v16, 0x3e0293ee, v16
    v_mul_f32 v17, 0x3e0293ee, v17
    v_mul_f32 v18, 0x3e0293ee, v18
    v_mul_f32 v19, 0x3e0293ee, v19
    v_mul_f32 v20, 0x3e0293ee, v20
    v_mul_f32 v21, 0x3e0293ee, v21
    v_mul_f32 v22, 0x3e0293ee, v22
    v_mul_f32 v23, 0x3e0293ee, v23
    v_cvt_pk_bf16_f32 v24, v8, v9
    v_cvt_pk_bf16_f32 v25, v10, v11
    v_cvt_pk_bf16_f32 v26, v12, v13
    v_cvt_pk_bf16_f32 v27, v14, v15
    v_cvt_pk_bf16_f32 v28, v16, v17
    v_cvt_pk_bf16_f32 v29, v18, v19
    v_cvt_pk_bf16_f32 v30, v20, v21
    v_cvt_pk_bf16_f32 v31, v22, v23
    s_nop 1
    v_permlane32_swap_b32 v24, v26
    v_permlane32_swap_b32 v25, v27
    buffer_store_dwordx4 v[24:27], v4, s[24:27], 0 offen offset:0
    v_permlane32_swap_b32 v28, v30
    v_permlane32_swap_b32 v29, v31
    buffer_store_dwordx4 v[28:31], v4, s[24:27], 0 offen offset:32
    s_nop 1
    v_add_u32 v3, 0x2000, v3
    v_add_u32 v4, 0x2000, v4
    v_accvgpr_read_b32 v8, a48
    v_accvgpr_read_b32 v9, a49
    v_accvgpr_read_b32 v10, a50
    v_accvgpr_read_b32 v11, a51
    v_accvgpr_read_b32 v12, a52
    v_accvgpr_read_b32 v13, a53
    v_accvgpr_read_b32 v14, a54
    v_accvgpr_read_b32 v15, a55
    v_accvgpr_read_b32 v16, a56
    v_accvgpr_read_b32 v17, a57
    v_accvgpr_read_b32 v18, a58
    v_accvgpr_read_b32 v19, a59
    v_accvgpr_read_b32 v20, a60
    v_accvgpr_read_b32 v21, a61
    v_accvgpr_read_b32 v22, a62
    v_accvgpr_read_b32 v23, a63
    v_mul_f32 v8, 0x3e0293ee, v8
    v_mul_f32 v9, 0x3e0293ee, v9
    v_mul_f32 v10, 0x3e0293ee, v10
    v_mul_f32 v11, 0x3e0293ee, v11
    v_mul_f32 v12, 0x3e0293ee, v12
    v_mul_f32 v13, 0x3e0293ee, v13
    v_mul_f32 v14, 0x3e0293ee, v14
    v_mul_f32 v15, 0x3e0293ee, v15
    v_mul_f32 v16, 0x3e0293ee, v16
    v_mul_f32 v17, 0x3e0293ee, v17
    v_mul_f32 v18, 0x3e0293ee, v18
    v_mul_f32 v19, 0x3e0293ee, v19
    v_mul_f32 v20, 0x3e0293ee, v20
    v_mul_f32 v21, 0x3e0293ee, v21
    v_mul_f32 v22, 0x3e0293ee, v22
    v_mul_f32 v23, 0x3e0293ee, v23
    v_cvt_pk_bf16_f32 v24, v8, v9
    v_cvt_pk_bf16_f32 v25, v10, v11
    v_cvt_pk_bf16_f32 v26, v12, v13
    v_cvt_pk_bf16_f32 v27, v14, v15
    v_cvt_pk_bf16_f32 v28, v16, v17
    v_cvt_pk_bf16_f32 v29, v18, v19
    v_cvt_pk_bf16_f32 v30, v20, v21
    v_cvt_pk_bf16_f32 v31, v22, v23
    s_nop 1
    v_permlane32_swap_b32 v24, v26
    v_permlane32_swap_b32 v25, v27
    buffer_store_dwordx4 v[24:27], v3, s[24:27], 0 offen offset:0
    v_permlane32_swap_b32 v28, v30
    v_permlane32_swap_b32 v29, v31
    buffer_store_dwordx4 v[28:31], v3, s[24:27], 0 offen offset:32
    s_nop 1
    v_accvgpr_read_b32 v8, a112
    v_accvgpr_read_b32 v9, a113
    v_accvgpr_read_b32 v10, a114
    v_accvgpr_read_b32 v11, a115
    v_accvgpr_read_b32 v12, a116
    v_accvgpr_read_b32 v13, a117
    v_accvgpr_read_b32 v14, a118
    v_accvgpr_read_b32 v15, a119
    v_accvgpr_read_b32 v16, a120
    v_accvgpr_read_b32 v17, a121
    v_accvgpr_read_b32 v18, a122
    v_accvgpr_read_b32 v19, a123
    v_accvgpr_read_b32 v20, a124
    v_accvgpr_read_b32 v21, a125
    v_accvgpr_read_b32 v22, a126
    v_accvgpr_read_b32 v23, a127
    v_mul_f32 v8, 0x3e0293ee, v8
    v_mul_f32 v9, 0x3e0293ee, v9
    v_mul_f32 v10, 0x3e0293ee, v10
    v_mul_f32 v11, 0x3e0293ee, v11
    v_mul_f32 v12, 0x3e0293ee, v12
    v_mul_f32 v13, 0x3e0293ee, v13
    v_mul_f32 v14, 0x3e0293ee, v14
    v_mul_f32 v15, 0x3e0293ee, v15
    v_mul_f32 v16, 0x3e0293ee, v16
    v_mul_f32 v17, 0x3e0293ee, v17
    v_mul_f32 v18, 0x3e0293ee, v18
    v_mul_f32 v19, 0x3e0293ee, v19
    v_mul_f32 v20, 0x3e0293ee, v20
    v_mul_f32 v21, 0x3e0293ee, v21
    v_mul_f32 v22, 0x3e0293ee, v22
    v_mul_f32 v23, 0x3e0293ee, v23
    v_cvt_pk_bf16_f32 v24, v8, v9
    v_cvt_pk_bf16_f32 v25, v10, v11
    v_cvt_pk_bf16_f32 v26, v12, v13
    v_cvt_pk_bf16_f32 v27, v14, v15
    v_cvt_pk_bf16_f32 v28, v16, v17
    v_cvt_pk_bf16_f32 v29, v18, v19
    v_cvt_pk_bf16_f32 v30, v20, v21
    v_cvt_pk_bf16_f32 v31, v22, v23
    s_nop 1
    v_permlane32_swap_b32 v24, v26
    v_permlane32_swap_b32 v25, v27
    buffer_store_dwordx4 v[24:27], v4, s[24:27], 0 offen offset:0
    v_permlane32_swap_b32 v28, v30
    v_permlane32_swap_b32 v29, v31
    buffer_store_dwordx4 v[28:31], v4, s[24:27], 0 offen offset:32
    s_nop 1
    s_branch k1_fin
k1_epi_gu:
    s_add_u32 s40, s6, 0x3000000
    s_addc_u32 s41, s7, 0
    s_mov_b32 s24, s40
    s_and_b32 s25, s41, 0xffff
    s_mov_b32 s26, 0x700000
    s_mov_b32 s27, 0x00020000
    s_sub_u32 s38, s16, 16
    s_lshl_b32 s38, s38, 19
    v_add_u32 v3, s38, v3
    s_mov_b32 s46, 0x3d372713
    s_mov_b32 s47, 0xc0135761
    v_accvgpr_read_b32 v8, a0
    v_accvgpr_read_b32 v24, a64
    v_accvgpr_read_b32 v9, a1
    v_accvgpr_read_b32 v25, a65
    v_accvgpr_read_b32 v10, a2
    v_accvgpr_read_b32 v26, a66
    v_accvgpr_read_b32 v11, a3
    v_accvgpr_read_b32 v27, a67
    v_accvgpr_read_b32 v12, a4
    v_accvgpr_read_b32 v28, a68
    v_accvgpr_read_b32 v13, a5
    v_accvgpr_read_b32 v29, a69
    v_accvgpr_read_b32 v14, a6
    v_accvgpr_read_b32 v30, a70
    v_accvgpr_read_b32 v15, a7
    v_accvgpr_read_b32 v31, a71
    v_accvgpr_read_b32 v16, a8
    v_accvgpr_read_b32 v32, a72
    v_accvgpr_read_b32 v17, a9
    v_accvgpr_read_b32 v33, a73
    v_accvgpr_read_b32 v18, a10
    v_accvgpr_read_b32 v34, a74
    v_accvgpr_read_b32 v19, a11
    v_accvgpr_read_b32 v35, a75
    v_accvgpr_read_b32 v20, a12
    v_accvgpr_read_b32 v36, a76
    v_accvgpr_read_b32 v21, a13
    v_accvgpr_read_b32 v37, a77
    v_accvgpr_read_b32 v22, a14
    v_accvgpr_read_b32 v38, a78
    v_accvgpr_read_b32 v23, a15
    v_accvgpr_read_b32 v39, a79
    v_cvt_pk_bf16_f32 v8, v8, v8
    v_lshlrev_b32 v8, 16, v8
    v_cvt_pk_bf16_f32 v24, v24, v24
    v_lshlrev_b32 v24, 16, v24
    v_mul_f32 v40, v8, v8
    v_fma_f32 v40, v40, s46, 1.0
    v_mul_f32 v40, v40, v8
    v_mul_f32 v40, s47, v40
    v_exp_f32 v40, v40
    v_cvt_pk_bf16_f32 v9, v9, v9
    v_lshlrev_b32 v9, 16, v9
    v_cvt_pk_bf16_f32 v25, v25, v25
    v_lshlrev_b32 v25, 16, v25
    v_mul_f32 v41, v9, v9
    v_fma_f32 v41, v41, s46, 1.0
    v_mul_f32 v41, v41, v9
    v_mul_f32 v41, s47, v41
    v_exp_f32 v41, v41
    v_cvt_pk_bf16_f32 v10, v10, v10
    v_lshlrev_b32 v10, 16, v10
    v_cvt_pk_bf16_f32 v26, v26, v26
    v_lshlrev_b32 v26, 16, v26
    v_mul_f32 v42, v10, v10
    v_fma_f32 v42, v42, s46, 1.0
    v_mul_f32 v42, v42, v10
    v_mul_f32 v42, s47, v42
    v_exp_f32 v42, v42
    v_cvt_pk_bf16_f32 v11, v11, v11
    v_lshlrev_b32 v11, 16, v11
    v_cvt_pk_bf16_f32 v27, v27, v27
    v_lshlrev_b32 v27, 16, v27
    v_mul_f32 v43, v11, v11
    v_fma_f32 v43, v43, s46, 1.0
    v_mul_f32 v43, v43, v11
    v_mul_f32 v43, s47, v43
    v_exp_f32 v43, v43
    v_cvt_pk_bf16_f32 v12, v12, v12
    v_lshlrev_b32 v12, 16, v12
    v_cvt_pk_bf16_f32 v28, v28, v28
    v_lshlrev_b32 v28, 16, v28
    v_mul_f32 v44, v12, v12
    v_fma_f32 v44, v44, s46, 1.0
    v_mul_f32 v44, v44, v12
    v_mul_f32 v44, s47, v44
    v_exp_f32 v44, v44
    v_cvt_pk_bf16_f32 v13, v13, v13
    v_lshlrev_b32 v13, 16, v13
    v_cvt_pk_bf16_f32 v29, v29, v29
    v_lshlrev_b32 v29, 16, v29
    v_mul_f32 v45, v13, v13
    v_fma_f32 v45, v45, s46, 1.0
    v_mul_f32 v45, v45, v13
    v_mul_f32 v45, s47, v45
    v_exp_f32 v45, v45
    v_cvt_pk_bf16_f32 v14, v14, v14
    v_lshlrev_b32 v14, 16, v14
    v_cvt_pk_bf16_f32 v30, v30, v30
    v_lshlrev_b32 v30, 16, v30
    v_mul_f32 v46, v14, v14
    v_fma_f32 v46, v46, s46, 1.0
    v_mul_f32 v46, v46, v14
    v_mul_f32 v46, s47, v46
    v_exp_f32 v46, v46
    v_cvt_pk_bf16_f32 v15, v15, v15
    v_lshlrev_b32 v15, 16, v15
    v_cvt_pk_bf16_f32 v31, v31, v31
    v_lshlrev_b32 v31, 16, v31
    v_mul_f32 v47, v15, v15
    v_fma_f32 v47, v47, s46, 1.0
    v_mul_f32 v47, v47, v15
    v_mul_f32 v47, s47, v47
    v_exp_f32 v47, v47
    v_cvt_pk_bf16_f32 v16, v16, v16
    v_lshlrev_b32 v16, 16, v16
    v_cvt_pk_bf16_f32 v32, v32, v32
    v_lshlrev_b32 v32, 16, v32
    v_mul_f32 v48, v16, v16
    v_fma_f32 v48, v48, s46, 1.0
    v_mul_f32 v48, v48, v16
    v_mul_f32 v48, s47, v48
    v_exp_f32 v48, v48
    v_cvt_pk_bf16_f32 v17, v17, v17
    v_lshlrev_b32 v17, 16, v17
    v_cvt_pk_bf16_f32 v33, v33, v33
    v_lshlrev_b32 v33, 16, v33
    v_mul_f32 v49, v17, v17
    v_fma_f32 v49, v49, s46, 1.0
    v_mul_f32 v49, v49, v17
    v_mul_f32 v49, s47, v49
    v_exp_f32 v49, v49
    v_cvt_pk_bf16_f32 v18, v18, v18
    v_lshlrev_b32 v18, 16, v18
    v_cvt_pk_bf16_f32 v34, v34, v34
    v_lshlrev_b32 v34, 16, v34
    v_mul_f32 v50, v18, v18
    v_fma_f32 v50, v50, s46, 1.0
    v_mul_f32 v50, v50, v18
    v_mul_f32 v50, s47, v50
    v_exp_f32 v50, v50
    v_cvt_pk_bf16_f32 v19, v19, v19
    v_lshlrev_b32 v19, 16, v19
    v_cvt_pk_bf16_f32 v35, v35, v35
    v_lshlrev_b32 v35, 16, v35
    v_mul_f32 v51, v19, v19
    v_fma_f32 v51, v51, s46, 1.0
    v_mul_f32 v51, v51, v19
    v_mul_f32 v51, s47, v51
    v_exp_f32 v51, v51
    v_cvt_pk_bf16_f32 v20, v20, v20
    v_lshlrev_b32 v20, 16, v20
    v_cvt_pk_bf16_f32 v36, v36, v36
    v_lshlrev_b32 v36, 16, v36
    v_mul_f32 v52, v20, v20
    v_fma_f32 v52, v52, s46, 1.0
    v_mul_f32 v52, v52, v20
    v_mul_f32 v52, s47, v52
    v_exp_f32 v52, v52
    v_cvt_pk_bf16_f32 v21, v21, v21
    v_lshlrev_b32 v21, 16, v21
    v_cvt_pk_bf16_f32 v37, v37, v37
    v_lshlrev_b32 v37, 16, v37
    v_mul_f32 v53, v21, v21
    v_fma_f32 v53, v53, s46, 1.0
    v_mul_f32 v53, v53, v21
    v_mul_f32 v53, s47, v53
    v_exp_f32 v53, v53
    v_cvt_pk_bf16_f32 v22, v22, v22
    v_lshlrev_b32 v22, 16, v22
    v_cvt_pk_bf16_f32 v38, v38, v38
    v_lshlrev_b32 v38, 16, v38
    v_mul_f32 v54, v22, v22
    v_fma_f32 v54, v54, s46, 1.0
    v_mul_f32 v54, v54, v22
    v_mul_f32 v54, s47, v54
    v_exp_f32 v54, v54
    v_cvt_pk_bf16_f32 v23, v23, v23
    v_lshlrev_b32 v23, 16, v23
    v_cvt_pk_bf16_f32 v39, v39, v39
    v_lshlrev_b32 v39, 16, v39
    v_mul_f32 v55, v23, v23
    v_fma_f32 v55, v55, s46, 1.0
    v_mul_f32 v55, v55, v23
    v_mul_f32 v55, s47, v55
    v_exp_f32 v55, v55
    v_add_f32 v40, 1.0, v40
    v_rcp_f32 v40, v40
    v_add_f32 v41, 1.0, v41
    v_rcp_f32 v41, v41
    v_add_f32 v42, 1.0, v42
    v_rcp_f32 v42, v42
    v_add_f32 v43, 1.0, v43
    v_rcp_f32 v43, v43
    v_add_f32 v44, 1.0, v44
    v_rcp_f32 v44, v44
    v_add_f32 v45, 1.0, v45
    v_rcp_f32 v45, v45
    v_add_f32 v46, 1.0, v46
    v_rcp_f32 v46, v46
    v_add_f32 v47, 1.0, v47
    v_rcp_f32 v47, v47
    v_add_f32 v48, 1.0, v48
    v_rcp_f32 v48, v48
    v_add_f32 v49, 1.0, v49
    v_rcp_f32 v49, v49
    v_add_f32 v50, 1.0, v50
    v_rcp_f32 v50, v50
    v_add_f32 v51, 1.0, v51
    v_rcp_f32 v51, v51
    v_add_f32 v52, 1.0, v52
    v_rcp_f32 v52, v52
    v_add_f32 v53, 1.0, v53
    v_rcp_f32 v53, v53
    v_add_f32 v54, 1.0, v54
    v_rcp_f32 v54, v54
    v_add_f32 v55, 1.0, v55
    v_rcp_f32 v55, v55
    v_mul_f32 v8, v8, v40
    v_cvt_pk_bf16_f32 v8, v8, v8
    v_lshlrev_b32 v8, 16, v8
    v_mul_f32 v8, v8, v24
    v_mul_f32 v9, v9, v41
    v_cvt_pk_bf16_f32 v9, v9, v9
    v_lshlrev_b32 v9, 16, v9
    v_mul_f32 v9, v9, v25
    v_mul_f32 v10, v10, v42
    v_cvt_pk_bf16_f32 v10, v10, v10
    v_lshlrev_b32 v10, 16, v10
    v_mul_f32 v10, v10, v26
    v_mul_f32 v11, v11, v43
    v_cvt_pk_bf16_f32 v11, v11, v11
    v_lshlrev_b32 v11, 16, v11
    v_mul_f32 v11, v11, v27
    v_mul_f32 v12, v12, v44
    v_cvt_pk_bf16_f32 v12, v12, v12
    v_lshlrev_b32 v12, 16, v12
    v_mul_f32 v12, v12, v28
    v_mul_f32 v13, v13, v45
    v_cvt_pk_bf16_f32 v13, v13, v13
    v_lshlrev_b32 v13, 16, v13
    v_mul_f32 v13, v13, v29
    v_mul_f32 v14, v14, v46
    v_cvt_pk_bf16_f32 v14, v14, v14
    v_lshlrev_b32 v14, 16, v14
    v_mul_f32 v14, v14, v30
    v_mul_f32 v15, v15, v47
    v_cvt_pk_bf16_f32 v15, v15, v15
    v_lshlrev_b32 v15, 16, v15
    v_mul_f32 v15, v15, v31
    v_mul_f32 v16, v16, v48
    v_cvt_pk_bf16_f32 v16, v16, v16
    v_lshlrev_b32 v16, 16, v16
    v_mul_f32 v16, v16, v32
    v_mul_f32 v17, v17, v49
    v_cvt_pk_bf16_f32 v17, v17, v17
    v_lshlrev_b32 v17, 16, v17
    v_mul_f32 v17, v17, v33
    v_mul_f32 v18, v18, v50
    v_cvt_pk_bf16_f32 v18, v18, v18
    v_lshlrev_b32 v18, 16, v18
    v_mul_f32 v18, v18, v34
    v_mul_f32 v19, v19, v51
    v_cvt_pk_bf16_f32 v19, v19, v19
    v_lshlrev_b32 v19, 16, v19
    v_mul_f32 v19, v19, v35
    v_mul_f32 v20, v20, v52
    v_cvt_pk_bf16_f32 v20, v20, v20
    v_lshlrev_b32 v20, 16, v20
    v_mul_f32 v20, v20, v36
    v_mul_f32 v21, v21, v53
    v_cvt_pk_bf16_f32 v21, v21, v21
    v_lshlrev_b32 v21, 16, v21
    v_mul_f32 v21, v21, v37
    v_mul_f32 v22, v22, v54
    v_cvt_pk_bf16_f32 v22, v22, v22
    v_lshlrev_b32 v22, 16, v22
    v_mul_f32 v22, v22, v38
    v_mul_f32 v23, v23, v55
    v_cvt_pk_bf16_f32 v23, v23, v23
    v_lshlrev_b32 v23, 16, v23
    v_mul_f32 v23, v23, v39
    v_cvt_pk_bf16_f32 v56, v8, v9
    v_cvt_pk_bf16_f32 v57, v10, v11
    v_cvt_pk_bf16_f32 v58, v12, v13
    v_cvt_pk_bf16_f32 v59, v14, v15
    v_cvt_pk_bf16_f32 v60, v16, v17
    v_cvt_pk_bf16_f32 v61, v18, v19
    v_cvt_pk_bf16_f32 v62, v20, v21
    v_cvt_pk_bf16_f32 v63, v22, v23
    s_nop 1
    v_permlane32_swap_b32 v56, v58
    v_permlane32_swap_b32 v57, v59
    buffer_store_dwordx4 v[56:59], v3, s[24:27], 0 offen offset:0
    v_permlane32_swap_b32 v60, v62
    v_permlane32_swap_b32 v61, v63
    buffer_store_dwordx4 v[60:63], v3, s[24:27], 0 offen offset:32
    s_nop 1
    v_add_u32 v3, 0x2000, v3
    v_accvgpr_read_b32 v8, a16
    v_accvgpr_read_b32 v24, a80
    v_accvgpr_read_b32 v9, a17
    v_accvgpr_read_b32 v25, a81
    v_accvgpr_read_b32 v10, a18
    v_accvgpr_read_b32 v26, a82
    v_accvgpr_read_b32 v11, a19
    v_accvgpr_read_b32 v27, a83
    v_accvgpr_read_b32 v12, a20
    v_accvgpr_read_b32 v28, a84
    v_accvgpr_read_b32 v13, a21
    v_accvgpr_read_b32 v29, a85
    v_accvgpr_read_b32 v14, a22
    v_accvgpr_read_b32 v30, a86
    v_accvgpr_read_b32 v15, a23
    v_accvgpr_read_b32 v31, a87
    v_accvgpr_read_b32 v16, a24
    v_accvgpr_read_b32 v32, a88
    v_accvgpr_read_b32 v17, a25
    v_accvgpr_read_b32 v33, a89
    v_accvgpr_read_b32 v18, a26
    v_accvgpr_read_b32 v34, a90
    v_accvgpr_read_b32 v19, a27
    v_accvgpr_read_b32 v35, a91
    v_accvgpr_read_b32 v20, a28
    v_accvgpr_read_b32 v36, a92
    v_accvgpr_read_b32 v21, a29
    v_accvgpr_read_b32 v37, a93
    v_accvgpr_read_b32 v22, a30
    v_accvgpr_read_b32 v38, a94
    v_accvgpr_read_b32 v23, a31
    v_accvgpr_read_b32 v39, a95
    v_cvt_pk_bf16_f32 v8, v8, v8
    v_lshlrev_b32 v8, 16, v8
    v_cvt_pk_bf16_f32 v24, v24, v24
    v_lshlrev_b32 v24, 16, v24
    v_mul_f32 v40, v8, v8
    v_fma_f32 v40, v40, s46, 1.0
    v_mul_f32 v40, v40, v8
    v_mul_f32 v40, s47, v40
    v_exp_f32 v40, v40
    v_cvt_pk_bf16_f32 v9, v9, v9
    v_lshlrev_b32 v9, 16, v9
    v_cvt_pk_bf16_f32 v25, v25, v25
    v_lshlrev_b32 v25, 16, v25
    v_mul_f32 v41, v9, v9
    v_fma_f32 v41, v41, s46, 1.0
    v_mul_f32 v41, v41, v9
    v_mul_f32 v41, s47, v41
    v_exp_f32 v41, v41
    v_cvt_pk_bf16_f32 v10, v10, v10
    v_lshlrev_b32 v10, 16, v10
    v_cvt_pk_bf16_f32 v26, v26, v26
    v_lshlrev_b32 v26, 16, v26
    v_mul_f32 v42, v10, v10
    v_fma_f32 v42, v42, s46, 1.0
    v_mul_f32 v42, v42, v10
    v_mul_f32 v42, s47, v42
    v_exp_f32 v42, v42
    v_cvt_pk_bf16_f32 v11, v11, v11
    v_lshlrev_b32 v11, 16, v11
    v_cvt_pk_bf16_f32 v27, v27, v27
    v_lshlrev_b32 v27, 16, v27
    v_mul_f32 v43, v11, v11
    v_fma_f32 v43, v43, s46, 1.0
    v_mul_f32 v43, v43, v11
    v_mul_f32 v43, s47, v43
    v_exp_f32 v43, v43
    v_cvt_pk_bf16_f32 v12, v12, v12
    v_lshlrev_b32 v12, 16, v12
    v_cvt_pk_bf16_f32 v28, v28, v28
    v_lshlrev_b32 v28, 16, v28
    v_mul_f32 v44, v12, v12
    v_fma_f32 v44, v44, s46, 1.0
    v_mul_f32 v44, v44, v12
    v_mul_f32 v44, s47, v44
    v_exp_f32 v44, v44
    v_cvt_pk_bf16_f32 v13, v13, v13
    v_lshlrev_b32 v13, 16, v13
    v_cvt_pk_bf16_f32 v29, v29, v29
    v_lshlrev_b32 v29, 16, v29
    v_mul_f32 v45, v13, v13
    v_fma_f32 v45, v45, s46, 1.0
    v_mul_f32 v45, v45, v13
    v_mul_f32 v45, s47, v45
    v_exp_f32 v45, v45
    v_cvt_pk_bf16_f32 v14, v14, v14
    v_lshlrev_b32 v14, 16, v14
    v_cvt_pk_bf16_f32 v30, v30, v30
    v_lshlrev_b32 v30, 16, v30
    v_mul_f32 v46, v14, v14
    v_fma_f32 v46, v46, s46, 1.0
    v_mul_f32 v46, v46, v14
    v_mul_f32 v46, s47, v46
    v_exp_f32 v46, v46
    v_cvt_pk_bf16_f32 v15, v15, v15
    v_lshlrev_b32 v15, 16, v15
    v_cvt_pk_bf16_f32 v31, v31, v31
    v_lshlrev_b32 v31, 16, v31
    v_mul_f32 v47, v15, v15
    v_fma_f32 v47, v47, s46, 1.0
    v_mul_f32 v47, v47, v15
    v_mul_f32 v47, s47, v47
    v_exp_f32 v47, v47
    v_cvt_pk_bf16_f32 v16, v16, v16
    v_lshlrev_b32 v16, 16, v16
    v_cvt_pk_bf16_f32 v32, v32, v32
    v_lshlrev_b32 v32, 16, v32
    v_mul_f32 v48, v16, v16
    v_fma_f32 v48, v48, s46, 1.0
    v_mul_f32 v48, v48, v16
    v_mul_f32 v48, s47, v48
    v_exp_f32 v48, v48
    v_cvt_pk_bf16_f32 v17, v17, v17
    v_lshlrev_b32 v17, 16, v17
    v_cvt_pk_bf16_f32 v33, v33, v33
    v_lshlrev_b32 v33, 16, v33
    v_mul_f32 v49, v17, v17
    v_fma_f32 v49, v49, s46, 1.0
    v_mul_f32 v49, v49, v17
    v_mul_f32 v49, s47, v49
    v_exp_f32 v49, v49
    v_cvt_pk_bf16_f32 v18, v18, v18
    v_lshlrev_b32 v18, 16, v18
    v_cvt_pk_bf16_f32 v34, v34, v34
    v_lshlrev_b32 v34, 16, v34
    v_mul_f32 v50, v18, v18
    v_fma_f32 v50, v50, s46, 1.0
    v_mul_f32 v50, v50, v18
    v_mul_f32 v50, s47, v50
    v_exp_f32 v50, v50
    v_cvt_pk_bf16_f32 v19, v19, v19
    v_lshlrev_b32 v19, 16, v19
    v_cvt_pk_bf16_f32 v35, v35, v35
    v_lshlrev_b32 v35, 16, v35
    v_mul_f32 v51, v19, v19
    v_fma_f32 v51, v51, s46, 1.0
    v_mul_f32 v51, v51, v19
    v_mul_f32 v51, s47, v51
    v_exp_f32 v51, v51
    v_cvt_pk_bf16_f32 v20, v20, v20
    v_lshlrev_b32 v20, 16, v20
    v_cvt_pk_bf16_f32 v36, v36, v36
    v_lshlrev_b32 v36, 16, v36
    v_mul_f32 v52, v20, v20
    v_fma_f32 v52, v52, s46, 1.0
    v_mul_f32 v52, v52, v20
    v_mul_f32 v52, s47, v52
    v_exp_f32 v52, v52
    v_cvt_pk_bf16_f32 v21, v21, v21
    v_lshlrev_b32 v21, 16, v21
    v_cvt_pk_bf16_f32 v37, v37, v37
    v_lshlrev_b32 v37, 16, v37
    v_mul_f32 v53, v21, v21
    v_fma_f32 v53, v53, s46, 1.0
    v_mul_f32 v53, v53, v21
    v_mul_f32 v53, s47, v53
    v_exp_f32 v53, v53
    v_cvt_pk_bf16_f32 v22, v22, v22
    v_lshlrev_b32 v22, 16, v22
    v_cvt_pk_bf16_f32 v38, v38, v38
    v_lshlrev_b32 v38, 16, v38
    v_mul_f32 v54, v22, v22
    v_fma_f32 v54, v54, s46, 1.0
    v_mul_f32 v54, v54, v22
    v_mul_f32 v54, s47, v54
    v_exp_f32 v54, v54
    v_cvt_pk_bf16_f32 v23, v23, v23
    v_lshlrev_b32 v23, 16, v23
    v_cvt_pk_bf16_f32 v39, v39, v39
    v_lshlrev_b32 v39, 16, v39
    v_mul_f32 v55, v23, v23
    v_fma_f32 v55, v55, s46, 1.0
    v_mul_f32 v55, v55, v23
    v_mul_f32 v55, s47, v55
    v_exp_f32 v55, v55
    v_add_f32 v40, 1.0, v40
    v_rcp_f32 v40, v40
    v_add_f32 v41, 1.0, v41
    v_rcp_f32 v41, v41
    v_add_f32 v42, 1.0, v42
    v_rcp_f32 v42, v42
    v_add_f32 v43, 1.0, v43
    v_rcp_f32 v43, v43
    v_add_f32 v44, 1.0, v44
    v_rcp_f32 v44, v44
    v_add_f32 v45, 1.0, v45
    v_rcp_f32 v45, v45
    v_add_f32 v46, 1.0, v46
    v_rcp_f32 v46, v46
    v_add_f32 v47, 1.0, v47
    v_rcp_f32 v47, v47
    v_add_f32 v48, 1.0, v48
    v_rcp_f32 v48, v48
    v_add_f32 v49, 1.0, v49
    v_rcp_f32 v49, v49
    v_add_f32 v50, 1.0, v50
    v_rcp_f32 v50, v50
    v_add_f32 v51, 1.0, v51
    v_rcp_f32 v51, v51
    v_add_f32 v52, 1.0, v52
    v_rcp_f32 v52, v52
    v_add_f32 v53, 1.0, v53
    v_rcp_f32 v53, v53
    v_add_f32 v54, 1.0, v54
    v_rcp_f32 v54, v54
    v_add_f32 v55, 1.0, v55
    v_rcp_f32 v55, v55
    v_mul_f32 v8, v8, v40
    v_cvt_pk_bf16_f32 v8, v8, v8
    v_lshlrev_b32 v8, 16, v8
    v_mul_f32 v8, v8, v24
    v_mul_f32 v9, v9, v41
    v_cvt_pk_bf16_f32 v9, v9, v9
    v_lshlrev_b32 v9, 16, v9
    v_mul_f32 v9, v9, v25
    v_mul_f32 v10, v10, v42
    v_cvt_pk_bf16_f32 v10, v10, v10
    v_lshlrev_b32 v10, 16, v10
    v_mul_f32 v10, v10, v26
    v_mul_f32 v11, v11, v43
    v_cvt_pk_bf16_f32 v11, v11, v11
    v_lshlrev_b32 v11, 16, v11
    v_mul_f32 v11, v11, v27
    v_mul_f32 v12, v12, v44
    v_cvt_pk_bf16_f32 v12, v12, v12
    v_lshlrev_b32 v12, 16, v12
    v_mul_f32 v12, v12, v28
    v_mul_f32 v13, v13, v45
    v_cvt_pk_bf16_f32 v13, v13, v13
    v_lshlrev_b32 v13, 16, v13
    v_mul_f32 v13, v13, v29
    v_mul_f32 v14, v14, v46
    v_cvt_pk_bf16_f32 v14, v14, v14
    v_lshlrev_b32 v14, 16, v14
    v_mul_f32 v14, v14, v30
    v_mul_f32 v15, v15, v47
    v_cvt_pk_bf16_f32 v15, v15, v15
    v_lshlrev_b32 v15, 16, v15
    v_mul_f32 v15, v15, v31
    v_mul_f32 v16, v16, v48
    v_cvt_pk_bf16_f32 v16, v16, v16
    v_lshlrev_b32 v16, 16, v16
    v_mul_f32 v16, v16, v32
    v_mul_f32 v17, v17, v49
    v_cvt_pk_bf16_f32 v17, v17, v17
    v_lshlrev_b32 v17, 16, v17
    v_mul_f32 v17, v17, v33
    v_mul_f32 v18, v18, v50
    v_cvt_pk_bf16_f32 v18, v18, v18
    v_lshlrev_b32 v18, 16, v18
    v_mul_f32 v18, v18, v34
    v_mul_f32 v19, v19, v51
    v_cvt_pk_bf16_f32 v19, v19, v19
    v_lshlrev_b32 v19, 16, v19
    v_mul_f32 v19, v19, v35
    v_mul_f32 v20, v20, v52
    v_cvt_pk_bf16_f32 v20, v20, v20
    v_lshlrev_b32 v20, 16, v20
    v_mul_f32 v20, v20, v36
    v_mul_f32 v21, v21, v53
    v_cvt_pk_bf16_f32 v21, v21, v21
    v_lshlrev_b32 v21, 16, v21
    v_mul_f32 v21, v21, v37
    v_mul_f32 v22, v22, v54
    v_cvt_pk_bf16_f32 v22, v22, v22
    v_lshlrev_b32 v22, 16, v22
    v_mul_f32 v22, v22, v38
    v_mul_f32 v23, v23, v55
    v_cvt_pk_bf16_f32 v23, v23, v23
    v_lshlrev_b32 v23, 16, v23
    v_mul_f32 v23, v23, v39
    v_cvt_pk_bf16_f32 v56, v8, v9
    v_cvt_pk_bf16_f32 v57, v10, v11
    v_cvt_pk_bf16_f32 v58, v12, v13
    v_cvt_pk_bf16_f32 v59, v14, v15
    v_cvt_pk_bf16_f32 v60, v16, v17
    v_cvt_pk_bf16_f32 v61, v18, v19
    v_cvt_pk_bf16_f32 v62, v20, v21
    v_cvt_pk_bf16_f32 v63, v22, v23
    s_nop 1
    v_permlane32_swap_b32 v56, v58
    v_permlane32_swap_b32 v57, v59
    buffer_store_dwordx4 v[56:59], v3, s[24:27], 0 offen offset:0
    v_permlane32_swap_b32 v60, v62
    v_permlane32_swap_b32 v61, v63
    buffer_store_dwordx4 v[60:63], v3, s[24:27], 0 offen offset:32
    s_nop 1
    v_add_u32 v3, 0x2000, v3
    v_accvgpr_read_b32 v8, a32
    v_accvgpr_read_b32 v24, a96
    v_accvgpr_read_b32 v9, a33
    v_accvgpr_read_b32 v25, a97
    v_accvgpr_read_b32 v10, a34
    v_accvgpr_read_b32 v26, a98
    v_accvgpr_read_b32 v11, a35
    v_accvgpr_read_b32 v27, a99
    v_accvgpr_read_b32 v12, a36
    v_accvgpr_read_b32 v28, a100
    v_accvgpr_read_b32 v13, a37
    v_accvgpr_read_b32 v29, a101
    v_accvgpr_read_b32 v14, a38
    v_accvgpr_read_b32 v30, a102
    v_accvgpr_read_b32 v15, a39
    v_accvgpr_read_b32 v31, a103
    v_accvgpr_read_b32 v16, a40
    v_accvgpr_read_b32 v32, a104
    v_accvgpr_read_b32 v17, a41
    v_accvgpr_read_b32 v33, a105
    v_accvgpr_read_b32 v18, a42
    v_accvgpr_read_b32 v34, a106
    v_accvgpr_read_b32 v19, a43
    v_accvgpr_read_b32 v35, a107
    v_accvgpr_read_b32 v20, a44
    v_accvgpr_read_b32 v36, a108
    v_accvgpr_read_b32 v21, a45
    v_accvgpr_read_b32 v37, a109
    v_accvgpr_read_b32 v22, a46
    v_accvgpr_read_b32 v38, a110
    v_accvgpr_read_b32 v23, a47
    v_accvgpr_read_b32 v39, a111
    v_cvt_pk_bf16_f32 v8, v8, v8
    v_lshlrev_b32 v8, 16, v8
    v_cvt_pk_bf16_f32 v24, v24, v24
    v_lshlrev_b32 v24, 16, v24
    v_mul_f32 v40, v8, v8
    v_fma_f32 v40, v40, s46, 1.0
    v_mul_f32 v40, v40, v8
    v_mul_f32 v40, s47, v40
    v_exp_f32 v40, v40
    v_cvt_pk_bf16_f32 v9, v9, v9
    v_lshlrev_b32 v9, 16, v9
    v_cvt_pk_bf16_f32 v25, v25, v25
    v_lshlrev_b32 v25, 16, v25
    v_mul_f32 v41, v9, v9
    v_fma_f32 v41, v41, s46, 1.0
    v_mul_f32 v41, v41, v9
    v_mul_f32 v41, s47, v41
    v_exp_f32 v41, v41
    v_cvt_pk_bf16_f32 v10, v10, v10
    v_lshlrev_b32 v10, 16, v10
    v_cvt_pk_bf16_f32 v26, v26, v26
    v_lshlrev_b32 v26, 16, v26
    v_mul_f32 v42, v10, v10
    v_fma_f32 v42, v42, s46, 1.0
    v_mul_f32 v42, v42, v10
    v_mul_f32 v42, s47, v42
    v_exp_f32 v42, v42
    v_cvt_pk_bf16_f32 v11, v11, v11
    v_lshlrev_b32 v11, 16, v11
    v_cvt_pk_bf16_f32 v27, v27, v27
    v_lshlrev_b32 v27, 16, v27
    v_mul_f32 v43, v11, v11
    v_fma_f32 v43, v43, s46, 1.0
    v_mul_f32 v43, v43, v11
    v_mul_f32 v43, s47, v43
    v_exp_f32 v43, v43
    v_cvt_pk_bf16_f32 v12, v12, v12
    v_lshlrev_b32 v12, 16, v12
    v_cvt_pk_bf16_f32 v28, v28, v28
    v_lshlrev_b32 v28, 16, v28
    v_mul_f32 v44, v12, v12
    v_fma_f32 v44, v44, s46, 1.0
    v_mul_f32 v44, v44, v12
    v_mul_f32 v44, s47, v44
    v_exp_f32 v44, v44
    v_cvt_pk_bf16_f32 v13, v13, v13
    v_lshlrev_b32 v13, 16, v13
    v_cvt_pk_bf16_f32 v29, v29, v29
    v_lshlrev_b32 v29, 16, v29
    v_mul_f32 v45, v13, v13
    v_fma_f32 v45, v45, s46, 1.0
    v_mul_f32 v45, v45, v13
    v_mul_f32 v45, s47, v45
    v_exp_f32 v45, v45
    v_cvt_pk_bf16_f32 v14, v14, v14
    v_lshlrev_b32 v14, 16, v14
    v_cvt_pk_bf16_f32 v30, v30, v30
    v_lshlrev_b32 v30, 16, v30
    v_mul_f32 v46, v14, v14
    v_fma_f32 v46, v46, s46, 1.0
    v_mul_f32 v46, v46, v14
    v_mul_f32 v46, s47, v46
    v_exp_f32 v46, v46
    v_cvt_pk_bf16_f32 v15, v15, v15
    v_lshlrev_b32 v15, 16, v15
    v_cvt_pk_bf16_f32 v31, v31, v31
    v_lshlrev_b32 v31, 16, v31
    v_mul_f32 v47, v15, v15
    v_fma_f32 v47, v47, s46, 1.0
    v_mul_f32 v47, v47, v15
    v_mul_f32 v47, s47, v47
    v_exp_f32 v47, v47
    v_cvt_pk_bf16_f32 v16, v16, v16
    v_lshlrev_b32 v16, 16, v16
    v_cvt_pk_bf16_f32 v32, v32, v32
    v_lshlrev_b32 v32, 16, v32
    v_mul_f32 v48, v16, v16
    v_fma_f32 v48, v48, s46, 1.0
    v_mul_f32 v48, v48, v16
    v_mul_f32 v48, s47, v48
    v_exp_f32 v48, v48
    v_cvt_pk_bf16_f32 v17, v17, v17
    v_lshlrev_b32 v17, 16, v17
    v_cvt_pk_bf16_f32 v33, v33, v33
    v_lshlrev_b32 v33, 16, v33
    v_mul_f32 v49, v17, v17
    v_fma_f32 v49, v49, s46, 1.0
    v_mul_f32 v49, v49, v17
    v_mul_f32 v49, s47, v49
    v_exp_f32 v49, v49
    v_cvt_pk_bf16_f32 v18, v18, v18
    v_lshlrev_b32 v18, 16, v18
    v_cvt_pk_bf16_f32 v34, v34, v34
    v_lshlrev_b32 v34, 16, v34
    v_mul_f32 v50, v18, v18
    v_fma_f32 v50, v50, s46, 1.0
    v_mul_f32 v50, v50, v18
    v_mul_f32 v50, s47, v50
    v_exp_f32 v50, v50
    v_cvt_pk_bf16_f32 v19, v19, v19
    v_lshlrev_b32 v19, 16, v19
    v_cvt_pk_bf16_f32 v35, v35, v35
    v_lshlrev_b32 v35, 16, v35
    v_mul_f32 v51, v19, v19
    v_fma_f32 v51, v51, s46, 1.0
    v_mul_f32 v51, v51, v19
    v_mul_f32 v51, s47, v51
    v_exp_f32 v51, v51
    v_cvt_pk_bf16_f32 v20, v20, v20
    v_lshlrev_b32 v20, 16, v20
    v_cvt_pk_bf16_f32 v36, v36, v36
    v_lshlrev_b32 v36, 16, v36
    v_mul_f32 v52, v20, v20
    v_fma_f32 v52, v52, s46, 1.0
    v_mul_f32 v52, v52, v20
    v_mul_f32 v52, s47, v52
    v_exp_f32 v52, v52
    v_cvt_pk_bf16_f32 v21, v21, v21
    v_lshlrev_b32 v21, 16, v21
    v_cvt_pk_bf16_f32 v37, v37, v37
    v_lshlrev_b32 v37, 16, v37
    v_mul_f32 v53, v21, v21
    v_fma_f32 v53, v53, s46, 1.0
    v_mul_f32 v53, v53, v21
    v_mul_f32 v53, s47, v53
    v_exp_f32 v53, v53
    v_cvt_pk_bf16_f32 v22, v22, v22
    v_lshlrev_b32 v22, 16, v22
    v_cvt_pk_bf16_f32 v38, v38, v38
    v_lshlrev_b32 v38, 16, v38
    v_mul_f32 v54, v22, v22
    v_fma_f32 v54, v54, s46, 1.0
    v_mul_f32 v54, v54, v22
    v_mul_f32 v54, s47, v54
    v_exp_f32 v54, v54
    v_cvt_pk_bf16_f32 v23, v23, v23
    v_lshlrev_b32 v23, 16, v23
    v_cvt_pk_bf16_f32 v39, v39, v39
    v_lshlrev_b32 v39, 16, v39
    v_mul_f32 v55, v23, v23
    v_fma_f32 v55, v55, s46, 1.0
    v_mul_f32 v55, v55, v23
    v_mul_f32 v55, s47, v55
    v_exp_f32 v55, v55
    v_add_f32 v40, 1.0, v40
    v_rcp_f32 v40, v40
    v_add_f32 v41, 1.0, v41
    v_rcp_f32 v41, v41
    v_add_f32 v42, 1.0, v42
    v_rcp_f32 v42, v42
    v_add_f32 v43, 1.0, v43
    v_rcp_f32 v43, v43
    v_add_f32 v44, 1.0, v44
    v_rcp_f32 v44, v44
    v_add_f32 v45, 1.0, v45
    v_rcp_f32 v45, v45
    v_add_f32 v46, 1.0, v46
    v_rcp_f32 v46, v46
    v_add_f32 v47, 1.0, v47
    v_rcp_f32 v47, v47
    v_add_f32 v48, 1.0, v48
    v_rcp_f32 v48, v48
    v_add_f32 v49, 1.0, v49
    v_rcp_f32 v49, v49
    v_add_f32 v50, 1.0, v50
    v_rcp_f32 v50, v50
    v_add_f32 v51, 1.0, v51
    v_rcp_f32 v51, v51
    v_add_f32 v52, 1.0, v52
    v_rcp_f32 v52, v52
    v_add_f32 v53, 1.0, v53
    v_rcp_f32 v53, v53
    v_add_f32 v54, 1.0, v54
    v_rcp_f32 v54, v54
    v_add_f32 v55, 1.0, v55
    v_rcp_f32 v55, v55
    v_mul_f32 v8, v8, v40
    v_cvt_pk_bf16_f32 v8, v8, v8
    v_lshlrev_b32 v8, 16, v8
    v_mul_f32 v8, v8, v24
    v_mul_f32 v9, v9, v41
    v_cvt_pk_bf16_f32 v9, v9, v9
    v_lshlrev_b32 v9, 16, v9
    v_mul_f32 v9, v9, v25
    v_mul_f32 v10, v10, v42
    v_cvt_pk_bf16_f32 v10, v10, v10
    v_lshlrev_b32 v10, 16, v10
    v_mul_f32 v10, v10, v26
    v_mul_f32 v11, v11, v43
    v_cvt_pk_bf16_f32 v11, v11, v11
    v_lshlrev_b32 v11, 16, v11
    v_mul_f32 v11, v11, v27
    v_mul_f32 v12, v12, v44
    v_cvt_pk_bf16_f32 v12, v12, v12
    v_lshlrev_b32 v12, 16, v12
    v_mul_f32 v12, v12, v28
    v_mul_f32 v13, v13, v45
    v_cvt_pk_bf16_f32 v13, v13, v13
    v_lshlrev_b32 v13, 16, v13
    v_mul_f32 v13, v13, v29
    v_mul_f32 v14, v14, v46
    v_cvt_pk_bf16_f32 v14, v14, v14
    v_lshlrev_b32 v14, 16, v14
    v_mul_f32 v14, v14, v30
    v_mul_f32 v15, v15, v47
    v_cvt_pk_bf16_f32 v15, v15, v15
    v_lshlrev_b32 v15, 16, v15
    v_mul_f32 v15, v15, v31
    v_mul_f32 v16, v16, v48
    v_cvt_pk_bf16_f32 v16, v16, v16
    v_lshlrev_b32 v16, 16, v16
    v_mul_f32 v16, v16, v32
    v_mul_f32 v17, v17, v49
    v_cvt_pk_bf16_f32 v17, v17, v17
    v_lshlrev_b32 v17, 16, v17
    v_mul_f32 v17, v17, v33
    v_mul_f32 v18, v18, v50
    v_cvt_pk_bf16_f32 v18, v18, v18
    v_lshlrev_b32 v18, 16, v18
    v_mul_f32 v18, v18, v34
    v_mul_f32 v19, v19, v51
    v_cvt_pk_bf16_f32 v19, v19, v19
    v_lshlrev_b32 v19, 16, v19
    v_mul_f32 v19, v19, v35
    v_mul_f32 v20, v20, v52
    v_cvt_pk_bf16_f32 v20, v20, v20
    v_lshlrev_b32 v20, 16, v20
    v_mul_f32 v20, v20, v36
    v_mul_f32 v21, v21, v53
    v_cvt_pk_bf16_f32 v21, v21, v21
    v_lshlrev_b32 v21, 16, v21
    v_mul_f32 v21, v21, v37
    v_mul_f32 v22, v22, v54
    v_cvt_pk_bf16_f32 v22, v22, v22
    v_lshlrev_b32 v22, 16, v22
    v_mul_f32 v22, v22, v38
    v_mul_f32 v23, v23, v55
    v_cvt_pk_bf16_f32 v23, v23, v23
    v_lshlrev_b32 v23, 16, v23
    v_mul_f32 v23, v23, v39
    v_cvt_pk_bf16_f32 v56, v8, v9
    v_cvt_pk_bf16_f32 v57, v10, v11
    v_cvt_pk_bf16_f32 v58, v12, v13
    v_cvt_pk_bf16_f32 v59, v14, v15
    v_cvt_pk_bf16_f32 v60, v16, v17
    v_cvt_pk_bf16_f32 v61, v18, v19
    v_cvt_pk_bf16_f32 v62, v20, v21
    v_cvt_pk_bf16_f32 v63, v22, v23
    s_nop 1
    v_permlane32_swap_b32 v56, v58
    v_permlane32_swap_b32 v57, v59
    buffer_store_dwordx4 v[56:59], v3, s[24:27], 0 offen offset:0
    v_permlane32_swap_b32 v60, v62
    v_permlane32_swap_b32 v61, v63
    buffer_store_dwordx4 v[60:63], v3, s[24:27], 0 offen offset:32
    s_nop 1
    v_add_u32 v3, 0x2000, v3
    v_accvgpr_read_b32 v8, a48
    v_accvgpr_read_b32 v24, a112
    v_accvgpr_read_b32 v9, a49
    v_accvgpr_read_b32 v25, a113
    v_accvgpr_read_b32 v10, a50
    v_accvgpr_read_b32 v26, a114
    v_accvgpr_read_b32 v11, a51
    v_accvgpr_read_b32 v27, a115
    v_accvgpr_read_b32 v12, a52
    v_accvgpr_read_b32 v28, a116
    v_accvgpr_read_b32 v13, a53
    v_accvgpr_read_b32 v29, a117
    v_accvgpr_read_b32 v14, a54
    v_accvgpr_read_b32 v30, a118
    v_accvgpr_read_b32 v15, a55
    v_accvgpr_read_b32 v31, a119
    v_accvgpr_read_b32 v16, a56
    v_accvgpr_read_b32 v32, a120
    v_accvgpr_read_b32 v17, a57
    v_accvgpr_read_b32 v33, a121
    v_accvgpr_read_b32 v18, a58
    v_accvgpr_read_b32 v34, a122
    v_accvgpr_read_b32 v19, a59
    v_accvgpr_read_b32 v35, a123
    v_accvgpr_read_b32 v20, a60
    v_accvgpr_read_b32 v36, a124
    v_accvgpr_read_b32 v21, a61
    v_accvgpr_read_b32 v37, a125
    v_accvgpr_read_b32 v22, a62
    v_accvgpr_read_b32 v38, a126
    v_accvgpr_read_b32 v23, a63
    v_accvgpr_read_b32 v39, a127
    v_cvt_pk_bf16_f32 v8, v8, v8
    v_lshlrev_b32 v8, 16, v8
    v_cvt_pk_bf16_f32 v24, v24, v24
    v_lshlrev_b32 v24, 16, v24
    v_mul_f32 v40, v8, v8
    v_fma_f32 v40, v40, s46, 1.0
    v_mul_f32 v40, v40, v8
    v_mul_f32 v40, s47, v40
    v_exp_f32 v40, v40
    v_cvt_pk_bf16_f32 v9, v9, v9
    v_lshlrev_b32 v9, 16, v9
    v_cvt_pk_bf16_f32 v25, v25, v25
    v_lshlrev_b32 v25, 16, v25
    v_mul_f32 v41, v9, v9
    v_fma_f32 v41, v41, s46, 1.0
    v_mul_f32 v41, v41, v9
    v_mul_f32 v41, s47, v41
    v_exp_f32 v41, v41
    v_cvt_pk_bf16_f32 v10, v10, v10
    v_lshlrev_b32 v10, 16, v10
    v_cvt_pk_bf16_f32 v26, v26, v26
    v_lshlrev_b32 v26, 16, v26
    v_mul_f32 v42, v10, v10
    v_fma_f32 v42, v42, s46, 1.0
    v_mul_f32 v42, v42, v10
    v_mul_f32 v42, s47, v42
    v_exp_f32 v42, v42
    v_cvt_pk_bf16_f32 v11, v11, v11
    v_lshlrev_b32 v11, 16, v11
    v_cvt_pk_bf16_f32 v27, v27, v27
    v_lshlrev_b32 v27, 16, v27
    v_mul_f32 v43, v11, v11
    v_fma_f32 v43, v43, s46, 1.0
    v_mul_f32 v43, v43, v11
    v_mul_f32 v43, s47, v43
    v_exp_f32 v43, v43
    v_cvt_pk_bf16_f32 v12, v12, v12
    v_lshlrev_b32 v12, 16, v12
    v_cvt_pk_bf16_f32 v28, v28, v28
    v_lshlrev_b32 v28, 16, v28
    v_mul_f32 v44, v12, v12
    v_fma_f32 v44, v44, s46, 1.0
    v_mul_f32 v44, v44, v12
    v_mul_f32 v44, s47, v44
    v_exp_f32 v44, v44
    v_cvt_pk_bf16_f32 v13, v13, v13
    v_lshlrev_b32 v13, 16, v13
    v_cvt_pk_bf16_f32 v29, v29, v29
    v_lshlrev_b32 v29, 16, v29
    v_mul_f32 v45, v13, v13
    v_fma_f32 v45, v45, s46, 1.0
    v_mul_f32 v45, v45, v13
    v_mul_f32 v45, s47, v45
    v_exp_f32 v45, v45
    v_cvt_pk_bf16_f32 v14, v14, v14
    v_lshlrev_b32 v14, 16, v14
    v_cvt_pk_bf16_f32 v30, v30, v30
    v_lshlrev_b32 v30, 16, v30
    v_mul_f32 v46, v14, v14
    v_fma_f32 v46, v46, s46, 1.0
    v_mul_f32 v46, v46, v14
    v_mul_f32 v46, s47, v46
    v_exp_f32 v46, v46
    v_cvt_pk_bf16_f32 v15, v15, v15
    v_lshlrev_b32 v15, 16, v15
    v_cvt_pk_bf16_f32 v31, v31, v31
    v_lshlrev_b32 v31, 16, v31
    v_mul_f32 v47, v15, v15
    v_fma_f32 v47, v47, s46, 1.0
    v_mul_f32 v47, v47, v15
    v_mul_f32 v47, s47, v47
    v_exp_f32 v47, v47
    v_cvt_pk_bf16_f32 v16, v16, v16
    v_lshlrev_b32 v16, 16, v16
    v_cvt_pk_bf16_f32 v32, v32, v32
    v_lshlrev_b32 v32, 16, v32
    v_mul_f32 v48, v16, v16
    v_fma_f32 v48, v48, s46, 1.0
    v_mul_f32 v48, v48, v16
    v_mul_f32 v48, s47, v48
    v_exp_f32 v48, v48
    v_cvt_pk_bf16_f32 v17, v17, v17
    v_lshlrev_b32 v17, 16, v17
    v_cvt_pk_bf16_f32 v33, v33, v33
    v_lshlrev_b32 v33, 16, v33
    v_mul_f32 v49, v17, v17
    v_fma_f32 v49, v49, s46, 1.0
    v_mul_f32 v49, v49, v17
    v_mul_f32 v49, s47, v49
    v_exp_f32 v49, v49
    v_cvt_pk_bf16_f32 v18, v18, v18
    v_lshlrev_b32 v18, 16, v18
    v_cvt_pk_bf16_f32 v34, v34, v34
    v_lshlrev_b32 v34, 16, v34
    v_mul_f32 v50, v18, v18
    v_fma_f32 v50, v50, s46, 1.0
    v_mul_f32 v50, v50, v18
    v_mul_f32 v50, s47, v50
    v_exp_f32 v50, v50
    v_cvt_pk_bf16_f32 v19, v19, v19
    v_lshlrev_b32 v19, 16, v19
    v_cvt_pk_bf16_f32 v35, v35, v35
    v_lshlrev_b32 v35, 16, v35
    v_mul_f32 v51, v19, v19
    v_fma_f32 v51, v51, s46, 1.0
    v_mul_f32 v51, v51, v19
    v_mul_f32 v51, s47, v51
    v_exp_f32 v51, v51
    v_cvt_pk_bf16_f32 v20, v20, v20
    v_lshlrev_b32 v20, 16, v20
    v_cvt_pk_bf16_f32 v36, v36, v36
    v_lshlrev_b32 v36, 16, v36
    v_mul_f32 v52, v20, v20
    v_fma_f32 v52, v52, s46, 1.0
    v_mul_f32 v52, v52, v20
    v_mul_f32 v52, s47, v52
    v_exp_f32 v52, v52
    v_cvt_pk_bf16_f32 v21, v21, v21
    v_lshlrev_b32 v21, 16, v21
    v_cvt_pk_bf16_f32 v37, v37, v37
    v_lshlrev_b32 v37, 16, v37
    v_mul_f32 v53, v21, v21
    v_fma_f32 v53, v53, s46, 1.0
    v_mul_f32 v53, v53, v21
    v_mul_f32 v53, s47, v53
    v_exp_f32 v53, v53
    v_cvt_pk_bf16_f32 v22, v22, v22
    v_lshlrev_b32 v22, 16, v22
    v_cvt_pk_bf16_f32 v38, v38, v38
    v_lshlrev_b32 v38, 16, v38
    v_mul_f32 v54, v22, v22
    v_fma_f32 v54, v54, s46, 1.0
    v_mul_f32 v54, v54, v22
    v_mul_f32 v54, s47, v54
    v_exp_f32 v54, v54
    v_cvt_pk_bf16_f32 v23, v23, v23
    v_lshlrev_b32 v23, 16, v23
    v_cvt_pk_bf16_f32 v39, v39, v39
    v_lshlrev_b32 v39, 16, v39
    v_mul_f32 v55, v23, v23
    v_fma_f32 v55, v55, s46, 1.0
    v_mul_f32 v55, v55, v23
    v_mul_f32 v55, s47, v55
    v_exp_f32 v55, v55
    v_add_f32 v40, 1.0, v40
    v_rcp_f32 v40, v40
    v_add_f32 v41, 1.0, v41
    v_rcp_f32 v41, v41
    v_add_f32 v42, 1.0, v42
    v_rcp_f32 v42, v42
    v_add_f32 v43, 1.0, v43
    v_rcp_f32 v43, v43
    v_add_f32 v44, 1.0, v44
    v_rcp_f32 v44, v44
    v_add_f32 v45, 1.0, v45
    v_rcp_f32 v45, v45
    v_add_f32 v46, 1.0, v46
    v_rcp_f32 v46, v46
    v_add_f32 v47, 1.0, v47
    v_rcp_f32 v47, v47
    v_add_f32 v48, 1.0, v48
    v_rcp_f32 v48, v48
    v_add_f32 v49, 1.0, v49
    v_rcp_f32 v49, v49
    v_add_f32 v50, 1.0, v50
    v_rcp_f32 v50, v50
    v_add_f32 v51, 1.0, v51
    v_rcp_f32 v51, v51
    v_add_f32 v52, 1.0, v52
    v_rcp_f32 v52, v52
    v_add_f32 v53, 1.0, v53
    v_rcp_f32 v53, v53
    v_add_f32 v54, 1.0, v54
    v_rcp_f32 v54, v54
    v_add_f32 v55, 1.0, v55
    v_rcp_f32 v55, v55
    v_mul_f32 v8, v8, v40
    v_cvt_pk_bf16_f32 v8, v8, v8
    v_lshlrev_b32 v8, 16, v8
    v_mul_f32 v8, v8, v24
    v_mul_f32 v9, v9, v41
    v_cvt_pk_bf16_f32 v9, v9, v9
    v_lshlrev_b32 v9, 16, v9
    v_mul_f32 v9, v9, v25
    v_mul_f32 v10, v10, v42
    v_cvt_pk_bf16_f32 v10, v10, v10
    v_lshlrev_b32 v10, 16, v10
    v_mul_f32 v10, v10, v26
    v_mul_f32 v11, v11, v43
    v_cvt_pk_bf16_f32 v11, v11, v11
    v_lshlrev_b32 v11, 16, v11
    v_mul_f32 v11, v11, v27
    v_mul_f32 v12, v12, v44
    v_cvt_pk_bf16_f32 v12, v12, v12
    v_lshlrev_b32 v12, 16, v12
    v_mul_f32 v12, v12, v28
    v_mul_f32 v13, v13, v45
    v_cvt_pk_bf16_f32 v13, v13, v13
    v_lshlrev_b32 v13, 16, v13
    v_mul_f32 v13, v13, v29
    v_mul_f32 v14, v14, v46
    v_cvt_pk_bf16_f32 v14, v14, v14
    v_lshlrev_b32 v14, 16, v14
    v_mul_f32 v14, v14, v30
    v_mul_f32 v15, v15, v47
    v_cvt_pk_bf16_f32 v15, v15, v15
    v_lshlrev_b32 v15, 16, v15
    v_mul_f32 v15, v15, v31
    v_mul_f32 v16, v16, v48
    v_cvt_pk_bf16_f32 v16, v16, v16
    v_lshlrev_b32 v16, 16, v16
    v_mul_f32 v16, v16, v32
    v_mul_f32 v17, v17, v49
    v_cvt_pk_bf16_f32 v17, v17, v17
    v_lshlrev_b32 v17, 16, v17
    v_mul_f32 v17, v17, v33
    v_mul_f32 v18, v18, v50
    v_cvt_pk_bf16_f32 v18, v18, v18
    v_lshlrev_b32 v18, 16, v18
    v_mul_f32 v18, v18, v34
    v_mul_f32 v19, v19, v51
    v_cvt_pk_bf16_f32 v19, v19, v19
    v_lshlrev_b32 v19, 16, v19
    v_mul_f32 v19, v19, v35
    v_mul_f32 v20, v20, v52
    v_cvt_pk_bf16_f32 v20, v20, v20
    v_lshlrev_b32 v20, 16, v20
    v_mul_f32 v20, v20, v36
    v_mul_f32 v21, v21, v53
    v_cvt_pk_bf16_f32 v21, v21, v21
    v_lshlrev_b32 v21, 16, v21
    v_mul_f32 v21, v21, v37
    v_mul_f32 v22, v22, v54
    v_cvt_pk_bf16_f32 v22, v22, v22
    v_lshlrev_b32 v22, 16, v22
    v_mul_f32 v22, v22, v38
    v_mul_f32 v23, v23, v55
    v_cvt_pk_bf16_f32 v23, v23, v23
    v_lshlrev_b32 v23, 16, v23
    v_mul_f32 v23, v23, v39
    v_cvt_pk_bf16_f32 v56, v8, v9
    v_cvt_pk_bf16_f32 v57, v10, v11
    v_cvt_pk_bf16_f32 v58, v12, v13
    v_cvt_pk_bf16_f32 v59, v14, v15
    v_cvt_pk_bf16_f32 v60, v16, v17
    v_cvt_pk_bf16_f32 v61, v18, v19
    v_cvt_pk_bf16_f32 v62, v20, v21
    v_cvt_pk_bf16_f32 v63, v22, v23
    s_nop 1
    v_permlane32_swap_b32 v56, v58
    v_permlane32_swap_b32 v57, v59
    buffer_store_dwordx4 v[56:59], v3, s[24:27], 0 offen offset:0
    v_permlane32_swap_b32 v60, v62
    v_permlane32_swap_b32 v61, v63
    buffer_store_dwordx4 v[60:63], v3, s[24:27], 0 offen offset:32
    s_nop 1
    s_branch k1_fin
k1_relayout:
    s_load_dwordx2 s[4:5], s[0:1], 32
    s_load_dwordx2 s[8:9], s[0:1], 64
    s_load_dwordx2 s[6:7], s[0:1], 88
    v_lshrrev_b32 v1, 6, v0
    v_and_b32 v0, 63, v0
    s_nop 0
    v_readfirstlane_b32 s18, v1
    s_sub_u32 s38, s16, 30
    s_lshl_b32 s39, s17, 1
    s_add_u32 s38, s38, s39
    s_lshl_b32 s38, s38, 3
    s_add_u32 s38, s38, s18
    s_mul_i32 s40, s38, 46
    s_waitcnt lgkmcnt(0)
    s_add_u32 s42, s6, 0x3800000
    s_addc_u32 s43, s7, 0
    s_mov_b32 s28, s42
    s_and_b32 s29, s43, 0xffff
    s_mov_b32 s30, 0x5c0000
    s_mov_b32 s31, 0x00020000
    s_and_b32 s5, s5, 0xffff
    s_and_b32 s9, s9, 0xffff
    v_lshlrev_b32 v1, 4, v0
    v_lshrrev_b32 v2, 4, v0
    s_mov_b32 s38, 0x170000
    v_mul_lo_u32 v2, v2, s38
    v_and_b32 v3, 15, v0
    v_lshl_add_u32 v2, v3, 4, v2
    s_mov_b32 s41, 0
    s_mov_b32 s47, 0x00020000
    s_mov_b32 s49, 0x1c0000
k1_rl_loop:
    s_add_u32 s38, s40, 0
    s_cmp_lt_u32 s38, 4096
    s_cselect_b32 s44, s4, s8
    s_cselect_b32 s45, s5, s9
    s_cselect_b32 s39, 0, 0x1000
    s_cselect_b32 s46, 0x400000, s49
    s_sub_u32 s39, s38, s39
    s_lshl_b32 s39, s39, 10
    buffer_load_dwordx4 v[8:11], v1, s[44:47], s39 offen
    s_add_u32 s38, s40, 1
    s_cmp_lt_u32 s38, 4096
    s_cselect_b32 s44, s4, s8
    s_cselect_b32 s45, s5, s9
    s_cselect_b32 s39, 0, 0x1000
    s_cselect_b32 s46, 0x400000, s49
    s_sub_u32 s39, s38, s39
    s_lshl_b32 s39, s39, 10
    buffer_load_dwordx4 v[12:15], v1, s[44:47], s39 offen
    s_add_u32 s38, s40, 2
    s_cmp_lt_u32 s38, 4096
    s_cselect_b32 s44, s4, s8
    s_cselect_b32 s45, s5, s9
    s_cselect_b32 s39, 0, 0x1000
    s_cselect_b32 s46, 0x400000, s49
    s_sub_u32 s39, s38, s39
    s_lshl_b32 s39, s39, 10
    buffer_load_dwordx4 v[16:19], v1, s[44:47], s39 offen
    s_add_u32 s38, s40, 3
    s_cmp_lt_u32 s38, 4096
    s_cselect_b32 s44, s4, s8
    s_cselect_b32 s45, s5, s9
    s_cselect_b32 s39, 0, 0x1000
    s_cselect_b32 s46, 0x400000, s49
    s_sub_u32 s39, s38, s39
    s_lshl_b32 s39, s39, 10
    buffer_load_dwordx4 v[20:23], v1, s[44:47], s39 offen
    s_add_u32 s38, s40, 4
    s_cmp_lt_u32 s38, 4096
    s_cselect_b32 s44, s4, s8
    s_cselect_b32 s45, s5, s9
    s_cselect_b32 s39, 0, 0x1000
    s_cselect_b32 s46, 0x400000, s49
    s_sub_u32 s39, s38, s39
    s_lshl_b32 s39, s39, 10
    buffer_load_dwordx4 v[24:27], v1, s[44:47], s39 offen
    s_add_u32 s38, s40, 5
    s_cmp_lt_u32 s38, 4096
    s_cselect_b32 s44, s4, s8
    s_cselect_b32 s45, s5, s9
    s_cselect_b32 s39, 0, 0x1000
    s_cselect_b32 s46, 0x400000, s49
    s_sub_u32 s39, s38, s39
    s_lshl_b32 s39, s39, 10
    buffer_load_dwordx4 v[28:31], v1, s[44:47], s39 offen
    s_add_u32 s38, s40, 6
    s_cmp_lt_u32 s38, 4096
    s_cselect_b32 s44, s4, s8
    s_cselect_b32 s45, s5, s9
    s_cselect_b32 s39, 0, 0x1000
    s_cselect_b32 s46, 0x400000, s49
    s_sub_u32 s39, s38, s39
    s_lshl_b32 s39, s39, 10
    buffer_load_dwordx4 v[32:35], v1, s[44:47], s39 offen
    s_add_u32 s38, s40, 7
    s_cmp_lt_u32 s38, 4096
    s_cselect_b32 s44, s4, s8
    s_cselect_b32 s45, s5, s9
    s_cselect_b32 s39, 0, 0x1000
    s_cselect_b32 s46, 0x400000, s49
    s_sub_u32 s39, s38, s39
    s_lshl_b32 s39, s39, 10
    buffer_load_dwordx4 v[36:39], v1, s[44:47], s39 offen
    s_add_u32 s38, s40, 8
    s_cmp_lt_u32 s38, 4096
    s_cselect_b32 s44, s4, s8
    s_cselect_b32 s45, s5, s9
    s_cselect_b32 s39, 0, 0x1000
    s_cselect_b32 s46, 0x400000, s49
    s_sub_u32 s39, s38, s39
    s_lshl_b32 s39, s39, 10
    buffer_load_dwordx4 v[40:43], v1, s[44:47], s39 offen
    s_add_u32 s38, s40, 9
    s_cmp_lt_u32 s38, 4096
    s_cselect_b32 s44, s4, s8
    s_cselect_b32 s45, s5, s9
    s_cselect_b32 s39, 0, 0x1000
    s_cselect_b32 s46, 0x400000, s49
    s_sub_u32 s39, s38, s39
    s_lshl_b32 s39, s39, 10
    buffer_load_dwordx4 v[44:47], v1, s[44:47], s39 offen
    s_add_u32 s38, s40, 10
    s_cmp_lt_u32 s38, 4096
    s_cselect_b32 s44, s4, s8
    s_cselect_b32 s45, s5, s9
    s_cselect_b32 s39, 0, 0x1000
    s_cselect_b32 s46, 0x400000, s49
    s_sub_u32 s39, s38, s39
    s_lshl_b32 s39, s39, 10
    buffer_load_dwordx4 v[48:51], v1, s[44:47], s39 offen
    s_add_u32 s38, s40, 11
    s_cmp_lt_u32 s38, 4096
    s_cselect_b32 s44, s4, s8
    s_cselect_b32 s45, s5, s9
    s_cselect_b32 s39, 0, 0x1000
    s_cselect_b32 s46, 0x400000, s49
    s_sub_u32 s39, s38, s39
    s_lshl_b32 s39, s39, 10
    buffer_load_dwordx4 v[52:55], v1, s[44:47], s39 offen
    s_add_u32 s38, s40, 12
    s_cmp_lt_u32 s38, 4096
    s_cselect_b32 s44, s4, s8
    s_cselect_b32 s45, s5, s9
    s_cselect_b32 s39, 0, 0x1000
    s_cselect_b32 s46, 0x400000, s49
    s_sub_u32 s39, s38, s39
    s_lshl_b32 s39, s39, 10
    buffer_load_dwordx4 v[56:59], v1, s[44:47], s39 offen
    s_add_u32 s38, s40, 13
    s_cmp_lt_u32 s38, 4096
    s_cselect_b32 s44, s4, s8
    s_cselect_b32 s45, s5, s9
    s_cselect_b32 s39, 0, 0x1000
    s_cselect_b32 s46, 0x400000, s49
    s_sub_u32 s39, s38, s39
    s_lshl_b32 s39, s39, 10
    buffer_load_dwordx4 v[60:63], v1, s[44:47], s39 offen
    s_add_u32 s38, s40, 14
    s_cmp_lt_u32 s38, 4096
    s_cselect_b32 s44, s4, s8
    s_cselect_b32 s45, s5, s9
    s_cselect_b32 s39, 0, 0x1000
    s_cselect_b32 s46, 0x400000, s49
    s_sub_u32 s39, s38, s39
    s_lshl_b32 s39, s39, 10
    buffer_load_dwordx4 v[64:67], v1, s[44:47], s39 offen
    s_add_u32 s38, s40, 15
    s_cmp_lt_u32 s38, 4096
    s_cselect_b32 s44, s4, s8
    s_cselect_b32 s45, s5, s9
    s_cselect_b32 s39, 0, 0x1000
    s_cselect_b32 s46, 0x400000, s49
    s_sub_u32 s39, s38, s39
    s_lshl_b32 s39, s39, 10
    buffer_load_dwordx4 v[68:71], v1, s[44:47], s39 offen
    s_add_u32 s38, s40, 16
    s_cmp_lt_u32 s38, 4096
    s_cselect_b32 s44, s4, s8
    s_cselect_b32 s45, s5, s9
    s_cselect_b32 s39, 0, 0x1000
    s_cselect_b32 s46, 0x400000, s49
    s_sub_u32 s39, s38, s39
    s_lshl_b32 s39, s39, 10
    buffer_load_dwordx4 v[72:75], v1, s[44:47], s39 offen
    s_add_u32 s38, s40, 17
    s_cmp_lt_u32 s38, 4096
    s_cselect_b32 s44, s4, s8
    s_cselect_b32 s45, s5, s9
    s_cselect_b32 s39, 0, 0x1000
    s_cselect_b32 s46, 0x400000, s49
    s_sub_u32 s39, s38, s39
    s_lshl_b32 s39, s39, 10
    buffer_load_dwordx4 v[76:79], v1, s[44:47], s39 offen
    s_add_u32 s38, s40, 18
    s_cmp_lt_u32 s38, 4096
    s_cselect_b32 s44, s4, s8
    s_cselect_b32 s45, s5, s9
    s_cselect_b32 s39, 0, 0x1000
    s_cselect_b32 s46, 0x400000, s49
    s_sub_u32 s39, s38, s39
    s_lshl_b32 s39, s39, 10
    buffer_load_dwordx4 v[80:83], v1, s[44:47], s39 offen
    s_add_u32 s38, s40, 19
    s_cmp_lt_u32 s38, 4096
    s_cselect_b32 s44, s4, s8
    s_cselect_b32 s45, s5, s9
    s_cselect_b32 s39, 0, 0x1000
    s_cselect_b32 s46, 0x400000, s49
    s_sub_u32 s39, s38, s39
    s_lshl_b32 s39, s39, 10
    buffer_load_dwordx4 v[84:87], v1, s[44:47], s39 offen
    s_add_u32 s38, s40, 20
    s_cmp_lt_u32 s38, 4096
    s_cselect_b32 s44, s4, s8
    s_cselect_b32 s45, s5, s9
    s_cselect_b32 s39, 0, 0x1000
    s_cselect_b32 s46, 0x400000, s49
    s_sub_u32 s39, s38, s39
    s_lshl_b32 s39, s39, 10
    buffer_load_dwordx4 v[88:91], v1, s[44:47], s39 offen
    s_add_u32 s38, s40, 21
    s_cmp_lt_u32 s38, 4096
    s_cselect_b32 s44, s4, s8
    s_cselect_b32 s45, s5, s9
    s_cselect_b32 s39, 0, 0x1000
    s_cselect_b32 s46, 0x400000, s49
    s_sub_u32 s39, s38, s39
    s_lshl_b32 s39, s39, 10
    buffer_load_dwordx4 v[92:95], v1, s[44:47], s39 offen
    s_add_u32 s38, s40, 22
    s_cmp_lt_u32 s38, 4096
    s_cselect_b32 s44, s4, s8
    s_cselect_b32 s45, s5, s9
    s_cselect_b32 s39, 0, 0x1000
    s_cselect_b32 s46, 0x400000, s49
    s_sub_u32 s39, s38, s39
    s_lshl_b32 s39, s39, 10
    buffer_load_dwordx4 v[96:99], v1, s[44:47], s39 offen
    s_add_u32 s38, s40, 0
    s_lshl_b32 s38, s38, 8
    s_waitcnt vmcnt(22)
    buffer_store_dwordx4 v[8:11], v2, s[28:31], s38 offen
    s_add_u32 s38, s40, 1
    s_lshl_b32 s38, s38, 8
    s_waitcnt vmcnt(22)
    buffer_store_dwordx4 v[12:15], v2, s[28:31], s38 offen
    s_add_u32 s38, s40, 2
    s_lshl_b32 s38, s38, 8
    s_waitcnt vmcnt(22)
    buffer_store_dwordx4 v[16:19], v2, s[28:31], s38 offen
    s_add_u32 s38, s40, 3
    s_lshl_b32 s38, s38, 8
    s_waitcnt vmcnt(22)
    buffer_store_dwordx4 v[20:23], v2, s[28:31], s38 offen
    s_add_u32 s38, s40, 4
    s_lshl_b32 s38, s38, 8
    s_waitcnt vmcnt(22)
    buffer_store_dwordx4 v[24:27], v2, s[28:31], s38 offen
    s_add_u32 s38, s40, 5
    s_lshl_b32 s38, s38, 8
    s_waitcnt vmcnt(22)
    buffer_store_dwordx4 v[28:31], v2, s[28:31], s38 offen
    s_add_u32 s38, s40, 6
    s_lshl_b32 s38, s38, 8
    s_waitcnt vmcnt(22)
    buffer_store_dwordx4 v[32:35], v2, s[28:31], s38 offen
    s_add_u32 s38, s40, 7
    s_lshl_b32 s38, s38, 8
    s_waitcnt vmcnt(22)
    buffer_store_dwordx4 v[36:39], v2, s[28:31], s38 offen
    s_add_u32 s38, s40, 8
    s_lshl_b32 s38, s38, 8
    s_waitcnt vmcnt(22)
    buffer_store_dwordx4 v[40:43], v2, s[28:31], s38 offen
    s_add_u32 s38, s40, 9
    s_lshl_b32 s38, s38, 8
    s_waitcnt vmcnt(22)
    buffer_store_dwordx4 v[44:47], v2, s[28:31], s38 offen
    s_add_u32 s38, s40, 10
    s_lshl_b32 s38, s38, 8
    s_waitcnt vmcnt(22)
    buffer_store_dwordx4 v[48:51], v2, s[28:31], s38 offen
    s_add_u32 s38, s40, 11
    s_lshl_b32 s38, s38, 8
    s_waitcnt vmcnt(22)
    buffer_store_dwordx4 v[52:55], v2, s[28:31], s38 offen
    s_add_u32 s38, s40, 12
    s_lshl_b32 s38, s38, 8
    s_waitcnt vmcnt(22)
    buffer_store_dwordx4 v[56:59], v2, s[28:31], s38 offen
    s_add_u32 s38, s40, 13
    s_lshl_b32 s38, s38, 8
    s_waitcnt vmcnt(22)
    buffer_store_dwordx4 v[60:63], v2, s[28:31], s38 offen
    s_add_u32 s38, s40, 14
    s_lshl_b32 s38, s38, 8
    s_waitcnt vmcnt(22)
    buffer_store_dwordx4 v[64:67], v2, s[28:31], s38 offen
    s_add_u32 s38, s40, 15
    s_lshl_b32 s38, s38, 8
    s_waitcnt vmcnt(22)
    buffer_store_dwordx4 v[68:71], v2, s[28:31], s38 offen
    s_add_u32 s38, s40, 16
    s_lshl_b32 s38, s38, 8
    s_waitcnt vmcnt(22)
    buffer_store_dwordx4 v[72:75], v2, s[28:31], s38 offen
    s_add_u32 s38, s40, 17
    s_lshl_b32 s38, s38, 8
    s_waitcnt vmcnt(22)
    buffer_store_dwordx4 v[76:79], v2, s[28:31], s38 offen
    s_add_u32 s38, s40, 18
    s_lshl_b32 s38, s38, 8
    s_waitcnt vmcnt(22)
    buffer_store_dwordx4 v[80:83], v2, s[28:31], s38 offen
    s_add_u32 s38, s40, 19
    s_lshl_b32 s38, s38, 8
    s_waitcnt vmcnt(22)
    buffer_store_dwordx4 v[84:87], v2, s[28:31], s38 offen
    s_add_u32 s38, s40, 20
    s_lshl_b32 s38, s38, 8
    s_waitcnt vmcnt(22)
    buffer_store_dwordx4 v[88:91], v2, s[28:31], s38 offen
    s_add_u32 s38, s40, 21
    s_lshl_b32 s38, s38, 8
    s_waitcnt vmcnt(22)
    buffer_store_dwordx4 v[92:95], v2, s[28:31], s38 offen
    s_add_u32 s38, s40, 22
    s_lshl_b32 s38, s38, 8
    s_waitcnt vmcnt(22)
    buffer_store_dwordx4 v[96:99], v2, s[28:31], s38 offen
    s_waitcnt vmcnt(0)
    s_add_u32 s40, s40, 23
    s_add_u32 s41, s41, 1
    s_cmp_lt_u32 s41, 2
    s_cbranch_scc1 k1_rl_loop
k1_fin:
k1_done:
    s_endpgm
.globl attn_kernel
.p2align 8
.type attn_kernel,@function
attn_kernel:
    s_cmp_ge_u32 s2, 256
    s_cbranch_scc1 at_done
    s_load_dwordx4 s[4:7], s[0:1], 8
    s_load_dwordx2 s[8:9], s[0:1], 88
    s_and_b32 s38, s2, 7
    s_lshr_b32 s39, s2, 3
    s_and_b32 s40, s39, 3
    s_lshl_b32 s16, s38, 2
    s_add_u32 s16, s16, s40
    s_lshr_b32 s17, s39, 2
    v_lshrrev_b32 v1, 6, v0
    v_and_b32 v140, 63, v0
    v_mov_b32 v0, v140
    s_nop 0
    v_readfirstlane_b32 s18, v1
    s_waitcnt lgkmcnt(0)
    s_mov_b32 s20, s4
    s_and_b32 s21, s5, 0xffff
    s_mov_b32 s22, 0x1000000
    s_mov_b32 s23, 0x00020000
    s_mov_b32 s24, s6
    s_and_b32 s25, s7, 0xffff
    s_mov_b32 s26, 0x1000000
    s_mov_b32 s27, 0x00020000
    s_lshl_b32 s28, s16, 19
    s_lshl_b32 s38, s18, 12
    s_add_u32 s28, s28, s38
    s_mov_b32 s29, s28
    s_mov_b32 s31, s38
    s_add_u32 s32, s38, 0x10000
    s_mov_b32 s36, 0x3e0293ee
    s_mov_b32 s37, 0x5d800000
    s_mov_b32 s48, 0x4000
    s_mov_b32 s49, 0xffff4000
    v_lshrrev_b32 v1, 4, v0
    v_and_b32 v2, 15, v0
    v_add_u32 v3, 0, v1
    v_xor_b32 v3, v2, v3
    v_lshlrev_b32 v3, 4, v3
    v_lshl_add_u32 v124, v1, 8, v3
    v_add_u32 v3, 4, v1
    v_xor_b32 v3, v2, v3
    v_lshlrev_b32 v3, 4, v3
    v_lshl_add_u32 v125, v1, 8, v3
    v_add_u32 v3, 8, v1
    v_xor_b32 v3, v2, v3
    v_lshlrev_b32 v3, 4, v3
    v_lshl_add_u32 v126, v1, 8, v3
    v_add_u32 v3, 12, v1
    v_xor_b32 v3, v2, v3
    v_lshlrev_b32 v3, 4, v3
    v_lshl_add_u32 v127, v1, 8, v3
    v_lshlrev_b32 v3, 2, v1
    v_xor_b32 v3, v2, v3
    v_lshlrev_b32 v3, 4, v3
    v_lshl_add_u32 v128, v1, 8, v3
    v_and_b32 v1, 31, v0
    v_lshrrev_b32 v2, 5, v0
    v_and_b32 v3, 15, v0
    v_lshlrev_b32 v4, 8, v1
    v_add_u32 v5, 0, v2
    v_xor_b32 v5, v5, v3
    v_lshl_add_u32 v112, v5, 4, v4
    v_add_u32 v5, 2, v2
    v_xor_b32 v5, v5, v3
    v_lshl_add_u32 v113, v5, 4, v4
    v_add_u32 v5, 4, v2
    v_xor_b32 v5, v5, v3
    v_lshl_add_u32 v114, v5, 4, v4
    v_add_u32 v5, 6, v2
    v_xor_b32 v5, v5, v3
    v_lshl_add_u32 v115, v5, 4, v4
    v_add_u32 v5, 8, v2
    v_xor_b32 v5, v5, v3
    v_lshl_add_u32 v116, v5, 4, v4
    v_add_u32 v5, 10, v2
    v_xor_b32 v5, v5, v3
    v_lshl_add_u32 v117, v5, 4, v4
    v_add_u32 v5, 12, v2
    v_xor_b32 v5, v5, v3
    v_lshl_add_u32 v118, v5, 4, v4
    v_add_u32 v5, 14, v2
    v_xor_b32 v5, v5, v3
    v_lshl_add_u32 v119, v5, 4, v4
    v_lshrrev_b32 v1, 4, v0
    v_and_b32 v1, 1, v1
    v_lshrrev_b32 v3, 2, v3
    v_and_b32 v4, 3, v0
    v_lshrrev_b32 v5, 1, v4
    v_lshl_add_u32 v5, v1, 1, v5
    v_lshl_add_u32 v6, v2, 2, v3
    v_lshlrev_b32 v6, 8, v6
    v_and_b32 v4, 1, v4
    v_lshl_add_u32 v6, v4, 3, v6
    v_add_u32 v6, 0x1c000, v6
    v_xor_b32 v7, 0, v3
    v_lshl_add_u32 v7, v7, 2, v5
    v_lshl_add_u32 v120, v7, 4, v6
    v_xor_b32 v7, 1, v3
    v_lshl_add_u32 v7, v7, 2, v5
    v_lshl_add_u32 v121, v7, 4, v6
    v_xor_b32 v7, 2, v3
    v_lshl_add_u32 v7, v7, 2, v5
    v_lshl_add_u32 v122, v7, 4, v6
    v_xor_b32 v7, 3, v3
    v_lshl_add_u32 v7, v7, 2, v5
    v_lshl_add_u32 v123, v7, 4, v6
    s_add_u32 s40, s8, 0x400000
    s_addc_u32 s41, s9, 0
    s_mov_b32 s44, s40
    s_and_b32 s45, s41, 0xffff
    s_mov_b32 s46, 0x1000000
    s_mov_b32 s47, 0x00020000
    v_and_b32 v1, 31, v0
    s_lshl_b32 s38, s17, 8
    s_lshl_b32 s39, s18, 6
    s_add_u32 s38, s38, s39
    v_add_u32 v1, s38, v1
    v_lshlrev_b32 v1, 8, v1
    v_lshl_add_u32 v1, v2, 4, v1
    s_lshl_b32 s38, s16, 19
    v_add_u32 v138, s38, v1
    v_add_u32 v139, 0x2000, v138
    buffer_load_dwordx4 a[128:131], v138, s[44:47], 0 offen offset:0
    buffer_load_dwordx4 a[132:135], v138, s[44:47], 0 offen offset:32
    buffer_load_dwordx4 a[136:139], v138, s[44:47], 0 offen offset:64
    buffer_load_dwordx4 a[140:143], v138, s[44:47], 0 offen offset:96
    buffer_load_dwordx4 a[144:147], v138, s[44:47], 0 offen offset:128
    buffer_load_dwordx4 a[148:151], v138, s[44:47], 0 offen offset:160
    buffer_load_dwordx4 a[152:155], v138, s[44:47], 0 offen offset:192
    buffer_load_dwordx4 a[156:159], v138, s[44:47], 0 offen offset:224
    buffer_load_dwordx4 a[160:163], v139, s[44:47], 0 offen offset:0
    buffer_load_dwordx4 a[164:167], v139, s[44:47], 0 offen offset:32
    buffer_load_dwordx4 a[168:171], v139, s[44:47], 0 offen offset:64
    buffer_load_dwordx4 a[172:175], v139, s[44:47], 0 offen offset:96
    buffer_load_dwordx4 a[176:179], v139, s[44:47], 0 offen offset:128
    buffer_load_dwordx4 a[180:183], v139, s[44:47], 0 offen offset:160
    buffer_load_dwordx4 a[184:187], v139, s[44:47], 0 offen offset:192
    buffer_load_dwordx4 a[188:191], v139, s[44:47], 0 offen offset:224
    s_mov_b32 s33, 0
    s_mov_b32 s34, 0xc000
    s_add_u32 m0, s31, s33
    s_nop 0
    buffer_load_dwordx4 v124, s[20:23], s28 offen offset:0 lds
    buffer_load_dwordx4 v125, s[20:23], s28 offen offset:1024 lds
    buffer_load_dwordx4 v126, s[20:23], s28 offen offset:2048 lds
    buffer_load_dwordx4 v127, s[20:23], s28 offen offset:3072 lds
    s_add_u32 s28, s28, 0x4000
    s_add_u32 s33, s33, 0x4000
    s_and_b32 s33, s33, 0xffff
    s_add_u32 m0, s32, s34
    s_nop 0
    buffer_load_dwordx4 v128, s[24:27], s29 offen offset:0 lds
    buffer_load_dwordx4 v128, s[24:27], s29 offen offset:1024 lds
    buffer_load_dwordx4 v128, s[24:27], s29 offen offset:2048 lds
    buffer_load_dwordx4 v128, s[24:27], s29 offen offset:3072 lds
    s_add_u32 s29, s29, 0x4000
    s_add_u32 s34, s34, 0x4000
    s_and_b32 s34, s34, 0xffff
    s_sub_u32 s29, s29, 0x4000
    s_add_u32 m0, s31, s33
    s_nop 0
    buffer_load_dwordx4 v124, s[20:23], s28 offen offset:0 lds
    buffer_load_dwordx4 v125, s[20:23], s28 offen offset:1024 lds
    buffer_load_dwordx4 v126, s[20:23], s28 offen offset:2048 lds
    buffer_load_dwordx4 v127, s[20:23], s28 offen offset:3072 lds
    s_add_u32 s28, s28, 0x4000
    s_add_u32 s33, s33, 0x4000
    s_and_b32 s33, s33, 0xffff
    s_add_u32 m0, s32, s34
    s_nop 0
    buffer_load_dwordx4 v128, s[24:27], s29 offen offset:0 lds
    buffer_load_dwordx4 v128, s[24:27], s29 offen offset:1024 lds
    buffer_load_dwordx4 v128, s[24:27], s29 offen offset:2048 lds
    buffer_load_dwordx4 v128, s[24:27], s29 offen offset:3072 lds
    s_add_u32 s29, s29, 0x4000
    s_add_u32 s34, s34, 0x4000
    s_and_b32 s34, s34, 0xffff
    s_add_u32 m0, s31, s33
    s_nop 0
    buffer_load_dwordx4 v124, s[20:23], s28 offen offset:0 lds
    buffer_load_dwordx4 v125, s[20:23], s28 offen offset:1024 lds
    buffer_load_dwordx4 v126, s[20:23], s28 offen offset:2048 lds
    buffer_load_dwordx4 v127, s[20:23], s28 offen offset:3072 lds
    s_add_u32 s28, s28, 0x4000
    s_add_u32 s33, s33, 0x4000
    s_and_b32 s33, s33, 0xffff
    s_add_u32 m0, s32, s34
    s_nop 0
    buffer_load_dwordx4 v128, s[24:27], s29 offen offset:0 lds
    buffer_load_dwordx4 v128, s[24:27], s29 offen offset:1024 lds
    buffer_load_dwordx4 v128, s[24:27], s29 offen offset:2048 lds
    buffer_load_dwordx4 v128, s[24:27], s29 offen offset:3072 lds
    s_add_u32 s29, s29, 0x4000
    s_add_u32 s34, s34, 0x4000
    s_and_b32 s34, s34, 0xffff
    v_accvgpr_write_b32 a0, 0
    v_accvgpr_write_b32 a1, 0
    v_accvgpr_write_b32 a2, 0
    v_accvgpr_write_b32 a3, 0
    v_accvgpr_write_b32 a4, 0
    v_accvgpr_write_b32 a5, 0
    v_accvgpr_write_b32 a6, 0
    v_accvgpr_write_b32 a7, 0
    v_accvgpr_write_b32 a8, 0
    v_accvgpr_write_b32 a9, 0
    v_accvgpr_write_b32 a10, 0
    v_accvgpr_write_b32 a11, 0
    v_accvgpr_write_b32 a12, 0
    v_accvgpr_write_b32 a13, 0
    v_accvgpr_write_b32 a14, 0
    v_accvgpr_write_b32 a15, 0
    v_accvgpr_write_b32 a16, 0
    v_accvgpr_write_b32 a17, 0
    v_accvgpr_write_b32 a18, 0
    v_accvgpr_write_b32 a19, 0
    v_accvgpr_write_b32 a20, 0
    v_accvgpr_write_b32 a21, 0
    v_accvgpr_write_b32 a22, 0
    v_accvgpr_write_b32 a23, 0
    v_accvgpr_write_b32 a24, 0
    v_accvgpr_write_b32 a25, 0
    v_accvgpr_write_b32 a26, 0
    v_accvgpr_write_b32 a27, 0
    v_accvgpr_write_b32 a28, 0
    v_accvgpr_write_b32 a29, 0
    v_accvgpr_write_b32 a30, 0
    v_accvgpr_write_b32 a31, 0
    v_accvgpr_write_b32 a32, 0
    v_accvgpr_write_b32 a33, 0
    v_accvgpr_write_b32 a34, 0
    v_accvgpr_write_b32 a35, 0
    v_accvgpr_write_b32 a36, 0
    v_accvgpr_write_b32 a37, 0
    v_accvgpr_write_b32 a38, 0
    v_accvgpr_write_b32 a39, 0
    v_accvgpr_write_b32 a40, 0
    v_accvgpr_write_b32 a41, 0
    v_accvgpr_write_b32 a42, 0
    v_accvgpr_write_b32 a43, 0
    v_accvgpr_write_b32 a44, 0
    v_accvgpr_write_b32 a45, 0
    v_accvgpr_write_b32 a46, 0
    v_accvgpr_write_b32 a47, 0
    v_accvgpr_write_b32 a48, 0
    v_accvgpr_write_b32 a49, 0
    v_accvgpr_write_b32 a50, 0
    v_accvgpr_write_b32 a51, 0
    v_accvgpr_write_b32 a52, 0
    v_accvgpr_write_b32 a53, 0
    v_accvgpr_write_b32 a54, 0
    v_accvgpr_write_b32 a55, 0
    v_accvgpr_write_b32 a56, 0
    v_accvgpr_write_b32 a57, 0
    v_accvgpr_write_b32 a58, 0
    v_accvgpr_write_b32 a59, 0
    v_accvgpr_write_b32 a60, 0
    v_accvgpr_write_b32 a61, 0
    v_accvgpr_write_b32 a62, 0
    v_accvgpr_write_b32 a63, 0
    v_accvgpr_write_b32 a64, 0
    v_accvgpr_write_b32 a65, 0
    v_accvgpr_write_b32 a66, 0
    v_accvgpr_write_b32 a67, 0
    v_accvgpr_write_b32 a68, 0
    v_accvgpr_write_b32 a69, 0
    v_accvgpr_write_b32 a70, 0
    v_accvgpr_write_b32 a71, 0
    v_accvgpr_write_b32 a72, 0
    v_accvgpr_write_b32 a73, 0
    v_accvgpr_write_b32 a74, 0
    v_accvgpr_write_b32 a75, 0
    v_accvgpr_write_b32 a76, 0
    v_accvgpr_write_b32 a77, 0
    v_accvgpr_write_b32 a78, 0
    v_accvgpr_write_b32 a79, 0
    v_accvgpr_write_b32 a80, 0
    v_accvgpr_write_b32 a81, 0
    v_accvgpr_write_b32 a82, 0
    v_accvgpr_write_b32 a83, 0
    v_accvgpr_write_b32 a84, 0
    v_accvgpr_write_b32 a85, 0
    v_accvgpr_write_b32 a86, 0
    v_accvgpr_write_b32 a87, 0
    v_accvgpr_write_b32 a88, 0
    v_accvgpr_write_b32 a89, 0
    v_accvgpr_write_b32 a90, 0
    v_accvgpr_write_b32 a91, 0
    v_accvgpr_write_b32 a92, 0
    v_accvgpr_write_b32 a93, 0
    v_accvgpr_write_b32 a94, 0
    v_accvgpr_write_b32 a95, 0
    v_accvgpr_write_b32 a96, 0
    v_accvgpr_write_b32 a97, 0
    v_accvgpr_write_b32 a98, 0
    v_accvgpr_write_b32 a99, 0
    v_accvgpr_write_b32 a100, 0
    v_accvgpr_write_b32 a101, 0
    v_accvgpr_write_b32 a102, 0
    v_accvgpr_write_b32 a103, 0
    v_accvgpr_write_b32 a104, 0
    v_accvgpr_write_b32 a105, 0
    v_accvgpr_write_b32 a106, 0
    v_accvgpr_write_b32 a107, 0
    v_accvgpr_write_b32 a108, 0
    v_accvgpr_write_b32 a109, 0
    v_accvgpr_write_b32 a110, 0
    v_accvgpr_write_b32 a111, 0
    v_accvgpr_write_b32 a112, 0
    v_accvgpr_write_b32 a113, 0
    v_accvgpr_write_b32 a114, 0
    v_accvgpr_write_b32 a115, 0
    v_accvgpr_write_b32 a116, 0
    v_accvgpr_write_b32 a117, 0
    v_accvgpr_write_b32 a118, 0
    v_accvgpr_write_b32 a119, 0
    v_accvgpr_write_b32 a120, 0
    v_accvgpr_write_b32 a121, 0
    v_accvgpr_write_b32 a122, 0
    v_accvgpr_write_b32 a123, 0
    v_accvgpr_write_b32 a124, 0
    v_accvgpr_write_b32 a125, 0
    v_accvgpr_write_b32 a126, 0
    v_accvgpr_write_b32 a127, 0
    v_mov_b32 v80, 0
    v_mov_b32 v81, 0
    v_mov_b32 v82, 0
    v_mov_b32 v83, 0
    v_mov_b32 v84, 0
    v_mov_b32 v85, 0
    v_mov_b32 v86, 0
    v_mov_b32 v87, 0
    v_mov_b32 v88, 0
    v_mov_b32 v89, 0
    v_mov_b32 v90, 0
    v_mov_b32 v91, 0
    v_mov_b32 v92, 0
    v_mov_b32 v93, 0
    v_mov_b32 v94, 0
    v_mov_b32 v95, 0
    v_mov_b32 v108, 0
    v_mov_b32 v109, 0
    v_mov_b32 v110, 0xff800000
    v_mov_b32 v111, 0xff800000
    s_waitcnt vmcnt(20)
    s_barrier
    ds_read_b128 a[192:195], v112 offset:0
    ds_read_b128 a[196:199], v113 offset:0
    ds_read_b128 a[200:203], v114 offset:0
    ds_read_b128 a[204:207], v115 offset:0
    s_waitcnt lgkmcnt(0)
    v_mfma_f32_32x32x16_bf16 v[0:15], a[192:195], a[128:131], 0
    v_mfma_f32_32x32x16_bf16 v[16:31], a[192:195], a[160:163], 0
    v_mfma_f32_32x32x16_bf16 v[0:15], a[196:199], a[132:135], v[0:15]
    v_mfma_f32_32x32x16_bf16 v[16:31], a[196:199], a[164:167], v[16:31]
    v_mfma_f32_32x32x16_bf16 v[0:15], a[200:203], a[136:139], v[0:15]
    v_mfma_f32_32x32x16_bf16 v[16:31], a[200:203], a[168:171], v[16:31]
    v_mfma_f32_32x32x16_bf16 v[0:15], a[204:207], a[140:143], v[0:15]
    v_mfma_f32_32x32x16_bf16 v[16:31], a[204:207], a[172:175], v[16:31]
    s_nop 7
    ds_read_b128 a[192:195], v116 offset:0
    ds_read_b128 a[196:199], v117 offset:0
    ds_read_b128 a[200:203], v118 offset:0
    ds_read_b128 a[204:207], v119 offset:0
    s_waitcnt lgkmcnt(0)
    v_mfma_f32_32x32x16_bf16 v[0:15], a[192:195], a[144:147], v[0:15]
    v_mfma_f32_32x32x16_bf16 v[16:31], a[192:195], a[176:179], v[16:31]
    v_mfma_f32_32x32x16_bf16 v[0:15], a[196:199], a[148:151], v[0:15]
    v_mfma_f32_32x32x16_bf16 v[16:31], a[196:199], a[180:183], v[16:31]
    v_mfma_f32_32x32x16_bf16 v[0:15], a[200:203], a[152:155], v[0:15]
    v_mfma_f32_32x32x16_bf16 v[16:31], a[200:203], a[184:187], v[16:31]
    v_mfma_f32_32x32x16_bf16 v[0:15], a[204:207], a[156:159], v[0:15]
    v_mfma_f32_32x32x16_bf16 v[16:31], a[204:207], a[188:191], v[16:31]
    s_nop 7
    s_nop 15
    v_max3_f32 v130, v0, v1, v2
    v_max3_f32 v130, v130, v3, v4
    v_max3_f32 v130, v130, v5, v6
    v_max3_f32 v130, v130, v7, v8
    v_max3_f32 v130, v130, v9, v10
    v_max3_f32 v130, v130, v11, v12
    v_max3_f32 v130, v130, v13, v14
    v_max_f32 v130, v130, v15
    v_mov_b32 v131, v130
    s_nop 1
    v_permlane32_swap_b32 v130, v131
    s_nop 1
    v_max_f32 v130, v130, v131
    v_sub_f32 v0, v0, v130
    v_sub_f32 v144, 0, v130
    v_sub_f32 v1, v1, v130
    v_sub_f32 v145, 0, v130
    v_sub_f32 v2, v2, v130
    v_sub_f32 v146, 0, v130
    v_sub_f32 v3, v3, v130
    v_sub_f32 v147, 0, v130
    v_sub_f32 v4, v4, v130
    v_sub_f32 v148, 0, v130
    v_sub_f32 v5, v5, v130
    v_sub_f32 v149, 0, v130
    v_sub_f32 v6, v6, v130
    v_sub_f32 v150, 0, v130
    v_sub_f32 v7, v7, v130
    v_sub_f32 v151, 0, v130
    v_sub_f32 v8, v8, v130
    v_sub_f32 v152, 0, v130
    v_sub_f32 v9, v9, v130
    v_sub_f32 v153, 0, v130
    v_sub_f32 v10, v10, v130
    v_sub_f32 v154, 0, v130
    v_sub_f32 v11, v11, v130
    v_sub_f32 v155, 0, v130
    v_sub_f32 v12, v12, v130
    v_sub_f32 v156, 0, v130
    v_sub_f32 v13, v13, v130
    v_sub_f32 v157, 0, v130
    v_sub_f32 v14, v14, v130
    v_sub_f32 v158, 0, v130
    v_sub_f32 v15, v15, v130
    v_sub_f32 v159, 0, v130
    v_max3_f32 v130, v16, v17, v18
    v_max3_f32 v130, v130, v19, v20
    v_max3_f32 v130, v130, v21, v22
    v_max3_f32 v130, v130, v23, v24
    v_max3_f32 v130, v130, v25, v26
    v_max3_f32 v130, v130, v27, v28
    v_max3_f32 v130, v130, v29, v30
    v_max_f32 v130, v130, v31
    v_mov_b32 v131, v130
    s_nop 1
    v_permlane32_swap_b32 v130, v131
    s_nop 1
    v_max_f32 v130, v130, v131
    v_sub_f32 v16, v16, v130
    v_sub_f32 v160, 0, v130
    v_sub_f32 v17, v17, v130
    v_sub_f32 v161, 0, v130
    v_sub_f32 v18, v18, v130
    v_sub_f32 v162, 0, v130
    v_sub_f32 v19, v19, v130
    v_sub_f32 v163, 0, v130
    v_sub_f32 v20, v20, v130
    v_sub_f32 v164, 0, v130
    v_sub_f32 v21, v21, v130
    v_sub_f32 v165, 0, v130
    v_sub_f32 v22, v22, v130
    v_sub_f32 v166, 0, v130
    v_sub_f32 v23, v23, v130
    v_sub_f32 v167, 0, v130
    v_sub_f32 v24, v24, v130
    v_sub_f32 v168, 0, v130
    v_sub_f32 v25, v25, v130
    v_sub_f32 v169, 0, v130
    v_sub_f32 v26, v26, v130
    v_sub_f32 v170, 0, v130
    v_sub_f32 v27, v27, v130
    v_sub_f32 v171, 0, v130
    v_sub_f32 v28, v28, v130
    v_sub_f32 v172, 0, v130
    v_sub_f32 v29, v29, v130
    v_sub_f32 v173, 0, v130
    v_sub_f32 v30, v30, v130
    v_sub_f32 v174, 0, v130
    v_sub_f32 v31, v31, v130
    v_sub_f32 v175, 0, v130
    s_waitcnt vmcnt(8)
    s_barrier
    ds_read_b128 a[192:195], v112 offset:8192
    ds_read_b128 a[196:199], v113 offset:8192
    ds_read_b128 a[200:203], v114 offset:8192
    s_mov_b32 s35, 0
    s_mov_b32 s46, 0
    s_mov_b32 s47, 3
at_loop:
    s_waitcnt lgkmcnt(2)
    v_mfma_f32_32x32x16_bf16 v[32:47], a[192:195], a[128:131], v[144:159]
    ds_read_b128 a[204:207], v115 offset:8192
    v_exp_f32 v96, v0
    v_exp_f32 v97, v1
    v_mfma_f32_32x32x16_bf16 v[48:63], a[192:195], a[160:163], v[160:175]
    v_exp_f32 v98, v2
    v_exp_f32 v99, v3
    v_exp_f32 v100, v4
    s_waitcnt lgkmcnt(2)
    v_mfma_f32_32x32x16_bf16 v[32:47], a[196:199], a[132:135], v[32:47]
    ds_read_b128 a[192:195], v116 offset:8192
    v_exp_f32 v101, v5
    v_mov_b32 v104, v96
    v_mov_b32 v105, v97
    v_mfma_f32_32x32x16_bf16 v[48:63], a[196:199], a[164:167], v[48:63]
    s_add_u32 m0, s31, s33
    s_nop 0
    buffer_load_dwordx4 v124, s[20:23], s28 offen offset:0 lds
    v_cvt_pk_bf16_f32 v64, v96, v97
    s_waitcnt lgkmcnt(2)
    v_mfma_f32_32x32x16_bf16 v[32:47], a[200:203], a[136:139], v[32:47]
    ds_read_b128 a[196:199], v117 offset:8192
    v_exp_f32 v102, v6
    v_exp_f32 v103, v7
    v_add_f32 v104, v104, v98
    v_mfma_f32_32x32x16_bf16 v[48:63], a[200:203], a[168:171], v[48:63]
    buffer_load_dwordx4 v125, s[20:23], s28 offen offset:1024 lds
    v_add_f32 v105, v105, v99
    v_cvt_pk_bf16_f32 v65, v98, v99
    s_waitcnt lgkmcnt(2)
    v_mfma_f32_32x32x16_bf16 v[32:47], a[204:207], a[140:143], v[32:47]
    ds_read_b128 a[200:203], v118 offset:8192
    v_exp_f32 v96, v8
    v_exp_f32 v97, v9
    v_mfma_f32_32x32x16_bf16 v[48:63], a[204:207], a[172:175], v[48:63]
    buffer_load_dwordx4 v126, s[20:23], s28 offen offset:2048 lds
    v_add_f32 v104, v104, v100
    v_add_f32 v105, v105, v101
    s_waitcnt lgkmcnt(2)
    v_mfma_f32_32x32x16_bf16 v[32:47], a[192:195], a[144:147], v[32:47]
    ds_read_b128 a[204:207], v119 offset:8192
    v_cvt_pk_bf16_f32 v66, v100, v101
    v_exp_f32 v98, v10
    v_exp_f32 v99, v11
    v_mfma_f32_32x32x16_bf16 v[48:63], a[192:195], a[176:179], v[48:63]
    buffer_load_dwordx4 v127, s[20:23], s28 offen offset:3072 lds
    s_add_u32 s28, s28, 0x4000
    s_add_u32 s33, s33, 0x4000
    s_and_b32 s33, s33, 0xffff
    s_waitcnt lgkmcnt(2)
    v_mfma_f32_32x32x16_bf16 v[32:47], a[196:199], a[148:151], v[32:47]
    ds_read_b64_tr_b16 a[192:193], v120 offset:8192
    ds_read_b64_tr_b16 a[194:195], v120 offset:10240
    v_add_f32 v104, v104, v102
    v_add_f32 v105, v105, v103
    v_cvt_pk_bf16_f32 v67, v102, v103
    v_mfma_f32_32x32x16_bf16 v[48:63], a[196:199], a[180:183], v[48:63]
    v_exp_f32 v100, v12
    v_exp_f32 v101, v13
    s_waitcnt lgkmcnt(3)
    v_mfma_f32_32x32x16_bf16 v[32:47], a[200:203], a[152:155], v[32:47]
    ds_read_b64_tr_b16 a[196:197], v120 offset:12288
    ds_read_b64_tr_b16 a[198:199], v120 offset:14336
    v_add_f32 v104, v104, v96
    v_add_f32 v105, v105, v97
    v_cvt_pk_bf16_f32 v68, v96, v97
    v_exp_f32 v102, v14
    v_mfma_f32_32x32x16_bf16 v[48:63], a[200:203], a[184:187], v[48:63]
    v_exp_f32 v103, v15
    v_add_f32 v104, v104, v98
    v_add_f32 v105, v105, v99
    s_waitcnt lgkmcnt(4)
    v_mfma_f32_32x32x16_bf16 v[32:47], a[204:207], a[156:159], v[32:47]
    ds_read_b64_tr_b16 a[200:201], v121 offset:8192
    ds_read_b64_tr_b16 a[202:203], v121 offset:10240
    v_cvt_pk_bf16_f32 v69, v98, v99
    v_exp_f32 v96, v16
    v_mfma_f32_32x32x16_bf16 v[48:63], a[204:207], a[188:191], v[48:63]
    v_exp_f32 v97, v17
    v_add_f32 v104, v104, v100
    v_add_f32 v105, v105, v101
    v_cvt_pk_bf16_f32 v70, v100, v101
    s_waitcnt lgkmcnt(4)
    v_mfma_f32_32x32x16_bf16 a[0:15], a[192:195], v[80:83], a[0:15]
    ds_read_b64_tr_b16 a[204:205], v121 offset:12288
    ds_read_b64_tr_b16 a[206:207], v121 offset:14336
    v_exp_f32 v98, v18
    v_exp_f32 v99, v19
    v_mfma_f32_32x32x16_bf16 a[64:79], a[192:195], v[88:91], a[64:79]
    s_add_u32 s46, s46, 1
    s_and_b32 s46, s46, 3
    s_cmp_eq_u32 s46, 0
    s_cselect_b32 s50, s49, s48
    v_add_u32 v112, s50, v112
    v_add_u32 v113, s50, v113
    v_add_u32 v114, s50, v114
    v_add_u32 v115, s50, v115
    s_waitcnt lgkmcnt(4)
    v_mfma_f32_32x32x16_bf16 a[0:15], a[196:199], v[84:87], a[0:15]
    ds_read_b64_tr_b16 a[192:193], v122 offset:8192
    ds_read_b64_tr_b16 a[194:195], v122 offset:10240
    v_add_f32 v104, v104, v102
    v_mfma_f32_32x32x16_bf16 a[64:79], a[196:199], v[92:95], a[64:79]
    v_add_u32 v116, s50, v116
    v_add_u32 v117, s50, v117
    v_add_u32 v118, s50, v118
    v_add_u32 v119, s50, v119
    s_waitcnt lgkmcnt(4)
    v_mfma_f32_32x32x16_bf16 a[16:31], a[200:203], v[80:83], a[16:31]
    ds_read_b64_tr_b16 a[196:197], v122 offset:12288
    ds_read_b64_tr_b16 a[198:199], v122 offset:14336
    v_add_f32 v105, v105, v103
    v_cvt_pk_bf16_f32 v71, v102, v103
    v_exp_f32 v100, v20
    v_mfma_f32_32x32x16_bf16 a[80:95], a[200:203], v[88:91], a[80:95]
    v_exp_f32 v101, v21
    v_mov_b32 v106, v96
    v_mov_b32 v107, v97
    v_cvt_pk_bf16_f32 v72, v96, v97
    s_waitcnt lgkmcnt(4)
    v_mfma_f32_32x32x16_bf16 a[16:31], a[204:207], v[84:87], a[16:31]
    ds_read_b64_tr_b16 a[200:201], v123 offset:8192
    ds_read_b64_tr_b16 a[202:203], v123 offset:10240
    v_exp_f32 v102, v22
    v_exp_f32 v103, v23
    v_mfma_f32_32x32x16_bf16 a[80:95], a[204:207], v[92:95], a[80:95]
    v_add_f32 v106, v106, v98
    v_add_f32 v107, v107, v99
    v_cvt_pk_bf16_f32 v73, v98, v99
    v_exp_f32 v96, v24
    s_waitcnt lgkmcnt(4)
    v_mfma_f32_32x32x16_bf16 a[32:47], a[192:195], v[80:83], a[32:47]
    ds_read_b64_tr_b16 a[204:205], v123 offset:12288
    ds_read_b64_tr_b16 a[206:207], v123 offset:14336
    v_exp_f32 v97, v25
    v_add_f32 v106, v106, v100
    v_mfma_f32_32x32x16_bf16 a[96:111], a[192:195], v[88:91], a[96:111]
    v_add_f32 v107, v107, v101
    v_cvt_pk_bf16_f32 v74, v100, v101
    v_exp_f32 v98, v26
    v_exp_f32 v99, v27
    s_waitcnt lgkmcnt(4)
    v_mfma_f32_32x32x16_bf16 a[32:47], a[196:199], v[84:87], a[32:47]
    ds_read_b128 a[192:195], v112 offset:0
    v_add_f32 v106, v106, v102
    v_add_f32 v107, v107, v103
    v_cvt_pk_bf16_f32 v75, v102, v103
    v_mfma_f32_32x32x16_bf16 a[96:111], a[196:199], v[92:95], a[96:111]
    v_exp_f32 v100, v28
    v_exp_f32 v101, v29
    v_add_f32 v106, v106, v96
    v_add_f32 v107, v107, v97
    s_waitcnt lgkmcnt(3)
    v_mfma_f32_32x32x16_bf16 a[48:63], a[200:203], v[80:83], a[48:63]
    ds_read_b128 a[196:199], v113 offset:0
    v_cvt_pk_bf16_f32 v76, v96, v97
    v_exp_f32 v102, v30
    v_exp_f32 v103, v31
    v_mfma_f32_32x32x16_bf16 a[112:127], a[200:203], v[88:91], a[112:127]
    v_add_f32 v106, v106, v98
    v_add_f32 v107, v107, v99
    v_cvt_pk_bf16_f32 v77, v98, v99
    v_add_f32 v106, v106, v100
    s_waitcnt lgkmcnt(2)
    v_mfma_f32_32x32x16_bf16 a[48:63], a[204:207], v[84:87], a[48:63]
    ds_read_b128 a[200:203], v114 offset:0
    v_add_f32 v107, v107, v101
    v_cvt_pk_bf16_f32 v78, v100, v101
    v_add_f32 v106, v106, v102
    v_add_f32 v107, v107, v103
    v_cvt_pk_bf16_f32 v79, v102, v103
    v_mfma_f32_32x32x16_bf16 a[112:127], a[204:207], v[92:95], a[112:127]
    v_add_f32 v104, v104, v105
    v_add_f32 v106, v106, v107
    v_max_f32 v130, v104, v106
    v_cmp_nge_f32 vcc, s37, v130
    s_cbranch_vccnz at_slow0
at_back0:
    v_add_f32 v108, v108, v104
    v_add_f32 v109, v109, v106
    s_waitcnt lgkmcnt(2)
    v_mfma_f32_32x32x16_bf16 v[0:15], a[192:195], a[128:131], v[144:159]
    ds_read_b128 a[204:207], v115 offset:0
    v_exp_f32 v96, v32
    v_exp_f32 v97, v33
    v_mfma_f32_32x32x16_bf16 v[16:31], a[192:195], a[160:163], v[160:175]
    s_add_u32 s47, s47, 1
    s_and_b32 s47, s47, 3
    s_cmp_eq_u32 s47, 0
    s_cselect_b32 s50, s49, s48
    v_add_u32 v120, s50, v120
    v_add_u32 v121, s50, v121
    v_add_u32 v122, s50, v122
    v_add_u32 v123, s50, v123
    s_waitcnt lgkmcnt(2)
    v_mfma_f32_32x32x16_bf16 v[0:15], a[196:199], a[132:135], v[0:15]
    ds_read_b128 a[192:195], v116 offset:0
    v_exp_f32 v98, v34
    v_mfma_f32_32x32x16_bf16 v[16:31], a[196:199], a[164:167], v[16:31]
    s_add_u32 m0, s32, s34
    s_nop 0
    buffer_load_dwordx4 v128, s[24:27], s29 offen offset:0 lds
    s_waitcnt lgkmcnt(2)
    v_mfma_f32_32x32x16_bf16 v[0:15], a[200:203], a[136:139], v[0:15]
    ds_read_b128 a[196:199], v117 offset:0
    v_exp_f32 v99, v35
    v_exp_f32 v100, v36
    v_exp_f32 v101, v37
    v_mfma_f32_32x32x16_bf16 v[16:31], a[200:203], a[168:171], v[16:31]
    buffer_load_dwordx4 v128, s[24:27], s29 offen offset:1024 lds
    v_mov_b32 v104, v96
    s_waitcnt lgkmcnt(2)
    v_mfma_f32_32x32x16_bf16 v[0:15], a[204:207], a[140:143], v[0:15]
    ds_read_b128 a[200:203], v118 offset:0
    v_mov_b32 v105, v97
    v_cvt_pk_bf16_f32 v80, v96, v97
    v_exp_f32 v102, v38
    v_mfma_f32_32x32x16_bf16 v[16:31], a[204:207], a[172:175], v[16:31]
    buffer_load_dwordx4 v128, s[24:27], s29 offen offset:2048 lds
    v_exp_f32 v103, v39
    s_waitcnt lgkmcnt(2)
    v_mfma_f32_32x32x16_bf16 v[0:15], a[192:195], a[144:147], v[0:15]
    ds_read_b128 a[204:207], v119 offset:0
    v_add_f32 v104, v104, v98
    v_add_f32 v105, v105, v99
    v_cvt_pk_bf16_f32 v81, v98, v99
    v_exp_f32 v96, v40
    v_mfma_f32_32x32x16_bf16 v[16:31], a[192:195], a[176:179], v[16:31]
    buffer_load_dwordx4 v128, s[24:27], s29 offen offset:3072 lds
    s_add_u32 s29, s29, 0x4000
    s_add_u32 s34, s34, 0x4000
    s_and_b32 s34, s34, 0xffff
    s_waitcnt lgkmcnt(2)
    v_mfma_f32_32x32x16_bf16 v[0:15], a[196:199], a[148:151], v[0:15]
    ds_read_b64_tr_b16 a[192:193], v120 offset:0
    ds_read_b64_tr_b16 a[194:195], v120 offset:2048
    v_exp_f32 v97, v41
    v_mfma_f32_32x32x16_bf16 v[16:31], a[196:199], a[180:183], v[16:31]
    v_add_f32 v104, v104, v100
    v_add_f32 v105, v105, v101
    v_cvt_pk_bf16_f32 v82, v100, v101
    v_exp_f32 v98, v42
    s_waitcnt lgkmcnt(3)
    v_mfma_f32_32x32x16_bf16 v[0:15], a[200:203], a[152:155], v[0:15]
    ds_read_b64_tr_b16 a[196:197], v120 offset:4096
    ds_read_b64_tr_b16 a[198:199], v120 offset:6144
    v_exp_f32 v99, v43
    v_add_f32 v104, v104, v102
    v_mfma_f32_32x32x16_bf16 v[16:31], a[200:203], a[184:187], v[16:31]
    v_add_f32 v105, v105, v103
    v_cvt_pk_bf16_f32 v83, v102, v103
    v_exp_f32 v100, v44
    v_exp_f32 v101, v45
    s_waitcnt lgkmcnt(4)
    v_mfma_f32_32x32x16_bf16 v[0:15], a[204:207], a[156:159], v[0:15]
    ds_read_b64_tr_b16 a[200:201], v121 offset:0
    ds_read_b64_tr_b16 a[202:203], v121 offset:2048
    v_add_f32 v104, v104, v96
    v_add_f32 v105, v105, v97
    v_cvt_pk_bf16_f32 v84, v96, v97
    v_mfma_f32_32x32x16_bf16 v[16:31], a[204:207], a[188:191], v[16:31]
    v_exp_f32 v102, v46
    v_exp_f32 v103, v47
    s_waitcnt lgkmcnt(4)
    v_mfma_f32_32x32x16_bf16 a[0:15], a[192:195], v[64:67], a[0:15]
    ds_read_b64_tr_b16 a[204:205], v121 offset:4096
    ds_read_b64_tr_b16 a[206:207], v121 offset:6144
    v_add_f32 v104, v104, v98
    v_add_f32 v105, v105, v99
    v_cvt_pk_bf16_f32 v85, v98, v99
    v_mfma_f32_32x32x16_bf16 a[64:79], a[192:195], v[72:75], a[64:79]
    v_exp_f32 v96, v48
    v_exp_f32 v97, v49
    v_add_f32 v104, v104, v100
    v_add_f32 v105, v105, v101
    s_waitcnt lgkmcnt(4)
    v_mfma_f32_32x32x16_bf16 a[0:15], a[196:199], v[68:71], a[0:15]
    ds_read_b64_tr_b16 a[192:193], v122 offset:0
    ds_read_b64_tr_b16 a[194:195], v122 offset:2048
    v_cvt_pk_bf16_f32 v86, v100, v101
    v_exp_f32 v98, v50
    v_mfma_f32_32x32x16_bf16 a[64:79], a[196:199], v[76:79], a[64:79]
    v_exp_f32 v99, v51
    v_add_f32 v104, v104, v102
    v_add_f32 v105, v105, v103
    v_cvt_pk_bf16_f32 v87, v102, v103
    s_waitcnt lgkmcnt(4)
    v_mfma_f32_32x32x16_bf16 a[16:31], a[200:203], v[64:67], a[16:31]
    ds_read_b64_tr_b16 a[196:197], v122 offset:4096
    ds_read_b64_tr_b16 a[198:199], v122 offset:6144
    v_exp_f32 v100, v52
    v_exp_f32 v101, v53
    v_mfma_f32_32x32x16_bf16 a[80:95], a[200:203], v[72:75], a[80:95]
    v_mov_b32 v106, v96
    v_mov_b32 v107, v97
    v_cvt_pk_bf16_f32 v88, v96, v97
    v_exp_f32 v102, v54
    s_waitcnt lgkmcnt(4)
    v_mfma_f32_32x32x16_bf16 a[16:31], a[204:207], v[68:71], a[16:31]
    ds_read_b64_tr_b16 a[200:201], v123 offset:0
    ds_read_b64_tr_b16 a[202:203], v123 offset:2048
    v_exp_f32 v103, v55
    v_add_f32 v106, v106, v98
    v_mfma_f32_32x32x16_bf16 a[80:95], a[204:207], v[76:79], a[80:95]
    v_add_f32 v107, v107, v99
    v_cvt_pk_bf16_f32 v89, v98, v99
    v_exp_f32 v96, v56
    s_waitcnt lgkmcnt(4)
    v_mfma_f32_32x32x16_bf16 a[32:47], a[192:195], v[64:67], a[32:47]
    ds_read_b64_tr_b16 a[204:205], v123 offset:4096
    ds_read_b64_tr_b16 a[206:207], v123 offset:6144
    v_exp_f32 v97, v57
    v_add_f32 v106, v106, v100
    v_add_f32 v107, v107, v101
    v_mfma_f32_32x32x16_bf16 a[96:111], a[192:195], v[72:75], a[96:111]
    v_cvt_pk_bf16_f32 v90, v100, v101
    v_exp_f32 v98, v58
    v_exp_f32 v99, v59
    s_waitcnt lgkmcnt(4)
    v_mfma_f32_32x32x16_bf16 a[32:47], a[196:199], v[68:71], a[32:47]
    ds_read_b128 a[192:195], v112 offset:8192
    v_add_f32 v106, v106, v102
    v_add_f32 v107, v107, v103
    v_cvt_pk_bf16_f32 v91, v102, v103
    v_exp_f32 v100, v60
    v_mfma_f32_32x32x16_bf16 a[96:111], a[196:199], v[76:79], a[96:111]
    v_exp_f32 v101, v61
    v_add_f32 v106, v106, v96
    v_add_f32 v107, v107, v97
    s_waitcnt lgkmcnt(3)
    v_mfma_f32_32x32x16_bf16 a[48:63], a[200:203], v[64:67], a[48:63]
    ds_read_b128 a[196:199], v113 offset:8192
    v_cvt_pk_bf16_f32 v92, v96, v97
    v_exp_f32 v102, v62
    v_exp_f32 v103, v63
    v_mfma_f32_32x32x16_bf16 a[112:127], a[200:203], v[72:75], a[112:127]
    v_add_f32 v106, v106, v98
    v_add_f32 v107, v107, v99
    v_cvt_pk_bf16_f32 v93, v98, v99
    v_add_f32 v106, v106, v100
    s_waitcnt lgkmcnt(2)
    v_mfma_f32_32x32x16_bf16 a[48:63], a[204:207], v[68:71], a[48:63]
    ds_read_b128 a[200:203], v114 offset:8192
    v_add_f32 v107, v107, v101
    v_cvt_pk_bf16_f32 v94, v100, v101
    v_add_f32 v106, v106, v102
    v_add_f32 v107, v107, v103
    v_cvt_pk_bf16_f32 v95, v102, v103
    v_mfma_f32_32x32x16_bf16 a[112:127], a[204:207], v[76:79], a[112:127]
    v_add_f32 v104, v104, v105
    v_add_f32 v106, v106, v107
    v_max_f32 v130, v104, v106
    v_cmp_nge_f32 vcc, s37, v130
    s_cbranch_vccnz at_slow1
at_back1:
    v_add_f32 v108, v108, v104
    v_add_f32 v109, v109, v106
    s_waitcnt vmcnt(8)
    s_barrier
    s_add_u32 s35, s35, 1
    s_cmp_lt_u32 s35, 32
    s_cbranch_scc1 at_loop
    s_waitcnt lgkmcnt(0)
    ds_read_b64_tr_b16 a[192:193], v120 offset:8192
    ds_read_b64_tr_b16 a[194:195], v120 offset:10240
    ds_read_b64_tr_b16 a[196:197], v120 offset:12288
    ds_read_b64_tr_b16 a[198:199], v120 offset:14336
    ds_read_b64_tr_b16 a[200:201], v121 offset:8192
    ds_read_b64_tr_b16 a[202:203], v121 offset:10240
    ds_read_b64_tr_b16 a[204:205], v121 offset:12288
    ds_read_b64_tr_b16 a[206:207], v121 offset:14336
    s_waitcnt lgkmcnt(0)
    v_mfma_f32_32x32x16_bf16 a[0:15], a[192:195], v[80:83], a[0:15]
    v_mfma_f32_32x32x16_bf16 a[64:79], a[192:195], v[88:91], a[64:79]
    v_mfma_f32_32x32x16_bf16 a[0:15], a[196:199], v[84:87], a[0:15]
    v_mfma_f32_32x32x16_bf16 a[64:79], a[196:199], v[92:95], a[64:79]
    v_mfma_f32_32x32x16_bf16 a[16:31], a[200:203], v[80:83], a[16:31]
    v_mfma_f32_32x32x16_bf16 a[80:95], a[200:203], v[88:91], a[80:95]
    v_mfma_f32_32x32x16_bf16 a[16:31], a[204:207], v[84:87], a[16:31]
    v_mfma_f32_32x32x16_bf16 a[80:95], a[204:207], v[92:95], a[80:95]
    s_nop 7
    ds_read_b64_tr_b16 a[192:193], v122 offset:8192
    ds_read_b64_tr_b16 a[194:195], v122 offset:10240
    ds_read_b64_tr_b16 a[196:197], v122 offset:12288
    ds_read_b64_tr_b16 a[198:199], v122 offset:14336
    ds_read_b64_tr_b16 a[200:201], v123 offset:8192
    ds_read_b64_tr_b16 a[202:203], v123 offset:10240
    ds_read_b64_tr_b16 a[204:205], v123 offset:12288
    ds_read_b64_tr_b16 a[206:207], v123 offset:14336
    s_waitcnt lgkmcnt(0)
    v_mfma_f32_32x32x16_bf16 a[32:47], a[192:195], v[80:83], a[32:47]
    v_mfma_f32_32x32x16_bf16 a[96:111], a[192:195], v[88:91], a[96:111]
    v_mfma_f32_32x32x16_bf16 a[32:47], a[196:199], v[84:87], a[32:47]
    v_mfma_f32_32x32x16_bf16 a[96:111], a[196:199], v[92:95], a[96:111]
    v_mfma_f32_32x32x16_bf16 a[48:63], a[200:203], v[80:83], a[48:63]
    v_mfma_f32_32x32x16_bf16 a[112:127], a[200:203], v[88:91], a[112:127]
    v_mfma_f32_32x32x16_bf16 a[48:63], a[204:207], v[84:87], a[48:63]
    v_mfma_f32_32x32x16_bf16 a[112:127], a[204:207], v[92:95], a[112:127]
    s_nop 7
    s_nop 15
    s_add_u32 s40, s8, 0x2000000
    s_addc_u32 s41, s9, 0
    s_mov_b32 s44, s40
    s_and_b32 s45, s41, 0xffff
    s_mov_b32 s46, 0x1000000
    s_mov_b32 s47, 0x00020000
    v_mov_b32 v130, v108
    s_nop 1
    v_permlane32_swap_b32 v108, v130
    s_nop 1
    v_add_f32 v130, v130, v108
    v_rcp_f32 v131, v130
    s_nop 0
    v_accvgpr_read_b32 v8, a0
    v_accvgpr_read_b32 v9, a1
    v_accvgpr_read_b32 v10, a2
    v_accvgpr_read_b32 v11, a3
    v_accvgpr_read_b32 v12, a4
    v_accvgpr_read_b32 v13, a5
    v_accvgpr_read_b32 v14, a6
    v_accvgpr_read_b32 v15, a7
    v_mul_f32 v8, v8, v131
    v_mul_f32 v9, v9, v131
    v_mul_f32 v10, v10, v131
    v_mul_f32 v11, v11, v131
    v_mul_f32 v12, v12, v131
    v_mul_f32 v13, v13, v131
    v_mul_f32 v14, v14, v131
    v_mul_f32 v15, v15, v131
    v_cvt_pk_bf16_f32 v16, v8, v9
    v_cvt_pk_bf16_f32 v17, v10, v11
    v_cvt_pk_bf16_f32 v18, v12, v13
    v_cvt_pk_bf16_f32 v19, v14, v15
    s_nop 1
    v_permlane32_swap_b32 v16, v18
    v_permlane32_swap_b32 v17, v19
    buffer_store_dwordx4 v[16:19], v138, s[44:47], 0 offen offset:0
    s_nop 1
    v_accvgpr_read_b32 v8, a8
    v_accvgpr_read_b32 v9, a9
    v_accvgpr_read_b32 v10, a10
    v_accvgpr_read_b32 v11, a11
    v_accvgpr_read_b32 v12, a12
    v_accvgpr_read_b32 v13, a13
    v_accvgpr_read_b32 v14, a14
    v_accvgpr_read_b32 v15, a15
    v_mul_f32 v8, v8, v131
    v_mul_f32 v9, v9, v131
    v_mul_f32 v10, v10, v131
    v_mul_f32 v11, v11, v131
    v_mul_f32 v12, v12, v131
    v_mul_f32 v13, v13, v131
    v_mul_f32 v14, v14, v131
    v_mul_f32 v15, v15, v131
    v_cvt_pk_bf16_f32 v16, v8, v9
    v_cvt_pk_bf16_f32 v17, v10, v11
    v_cvt_pk_bf16_f32 v18, v12, v13
    v_cvt_pk_bf16_f32 v19, v14, v15
    s_nop 1
    v_permlane32_swap_b32 v16, v18
    v_permlane32_swap_b32 v17, v19
    buffer_store_dwordx4 v[16:19], v138, s[44:47], 0 offen offset:32
    s_nop 1
    v_accvgpr_read_b32 v8, a16
    v_accvgpr_read_b32 v9, a17
    v_accvgpr_read_b32 v10, a18
    v_accvgpr_read_b32 v11, a19
    v_accvgpr_read_b32 v12, a20
    v_accvgpr_read_b32 v13, a21
    v_accvgpr_read_b32 v14, a22
    v_accvgpr_read_b32 v15, a23
    v_mul_f32 v8, v8, v131
    v_mul_f32 v9, v9, v131
    v_mul_f32 v10, v10, v131
    v_mul_f32 v11, v11, v131
    v_mul_f32 v12, v12, v131
    v_mul_f32 v13, v13, v131
    v_mul_f32 v14, v14, v131
    v_mul_f32 v15, v15, v131
    v_cvt_pk_bf16_f32 v16, v8, v9
    v_cvt_pk_bf16_f32 v17, v10, v11
    v_cvt_pk_bf16_f32 v18, v12, v13
    v_cvt_pk_bf16_f32 v19, v14, v15
    s_nop 1
    v_permlane32_swap_b32 v16, v18
    v_permlane32_swap_b32 v17, v19
    buffer_store_dwordx4 v[16:19], v138, s[44:47], 0 offen offset:64
    s_nop 1
    v_accvgpr_read_b32 v8, a24
    v_accvgpr_read_b32 v9, a25
    v_accvgpr_read_b32 v10, a26
    v_accvgpr_read_b32 v11, a27
    v_accvgpr_read_b32 v12, a28
    v_accvgpr_read_b32 v13, a29
    v_accvgpr_read_b32 v14, a30
    v_accvgpr_read_b32 v15, a31
    v_mul_f32 v8, v8, v131
    v_mul_f32 v9, v9, v131
    v_mul_f32 v10, v10, v131
    v_mul_f32 v11, v11, v131
    v_mul_f32 v12, v12, v131
    v_mul_f32 v13, v13, v131
    v_mul_f32 v14, v14, v131
    v_mul_f32 v15, v15, v131
    v_cvt_pk_bf16_f32 v16, v8, v9
    v_cvt_pk_bf16_f32 v17, v10, v11
    v_cvt_pk_bf16_f32 v18, v12, v13
    v_cvt_pk_bf16_f32 v19, v14, v15
    s_nop 1
    v_permlane32_swap_b32 v16, v18
    v_permlane32_swap_b32 v17, v19
    buffer_store_dwordx4 v[16:19], v138, s[44:47], 0 offen offset:96
    s_nop 1
    v_accvgpr_read_b32 v8, a32
    v_accvgpr_read_b32 v9, a33
    v_accvgpr_read_b32 v10, a34
    v_accvgpr_read_b32 v11, a35
    v_accvgpr_read_b32 v12, a36
    v_accvgpr_read_b32 v13, a37
    v_accvgpr_read_b32 v14, a38
    v_accvgpr_read_b32 v15, a39
    v_mul_f32 v8, v8, v131
    v_mul_f32 v9, v9, v131
    v_mul_f32 v10, v10, v131
    v_mul_f32 v11, v11, v131
    v_mul_f32 v12, v12, v131
    v_mul_f32 v13, v13, v131
    v_mul_f32 v14, v14, v131
    v_mul_f32 v15, v15, v131
    v_cvt_pk_bf16_f32 v16, v8, v9
    v_cvt_pk_bf16_f32 v17, v10, v11
    v_cvt_pk_bf16_f32 v18, v12, v13
    v_cvt_pk_bf16_f32 v19, v14, v15
    s_nop 1
    v_permlane32_swap_b32 v16, v18
    v_permlane32_swap_b32 v17, v19
    buffer_store_dwordx4 v[16:19], v138, s[44:47], 0 offen offset:128
    s_nop 1
    v_accvgpr_read_b32 v8, a40
    v_accvgpr_read_b32 v9, a41
    v_accvgpr_read_b32 v10, a42
    v_accvgpr_read_b32 v11, a43
    v_accvgpr_read_b32 v12, a44
    v_accvgpr_read_b32 v13, a45
    v_accvgpr_read_b32 v14, a46
    v_accvgpr_read_b32 v15, a47
    v_mul_f32 v8, v8, v131
    v_mul_f32 v9, v9, v131
    v_mul_f32 v10, v10, v131
    v_mul_f32 v11, v11, v131
    v_mul_f32 v12, v12, v131
    v_mul_f32 v13, v13, v131
    v_mul_f32 v14, v14, v131
    v_mul_f32 v15, v15, v131
    v_cvt_pk_bf16_f32 v16, v8, v9
    v_cvt_pk_bf16_f32 v17, v10, v11
    v_cvt_pk_bf16_f32 v18, v12, v13
    v_cvt_pk_bf16_f32 v19, v14, v15
    s_nop 1
    v_permlane32_swap_b32 v16, v18
    v_permlane32_swap_b32 v17, v19
    buffer_store_dwordx4 v[16:19], v138, s[44:47], 0 offen offset:160
    s_nop 1
    v_accvgpr_read_b32 v8, a48
    v_accvgpr_read_b32 v9, a49
    v_accvgpr_read_b32 v10, a50
    v_accvgpr_read_b32 v11, a51
    v_accvgpr_read_b32 v12, a52
    v_accvgpr_read_b32 v13, a53
    v_accvgpr_read_b32 v14, a54
    v_accvgpr_read_b32 v15, a55
    v_mul_f32 v8, v8, v131
    v_mul_f32 v9, v9, v131
    v_mul_f32 v10, v10, v131
    v_mul_f32 v11, v11, v131
    v_mul_f32 v12, v12, v131
    v_mul_f32 v13, v13, v131
    v_mul_f32 v14, v14, v131
    v_mul_f32 v15, v15, v131
    v_cvt_pk_bf16_f32 v16, v8, v9
    v_cvt_pk_bf16_f32 v17, v10, v11
    v_cvt_pk_bf16_f32 v18, v12, v13
    v_cvt_pk_bf16_f32 v19, v14, v15
    s_nop 1
    v_permlane32_swap_b32 v16, v18
    v_permlane32_swap_b32 v17, v19
    buffer_store_dwordx4 v[16:19], v138, s[44:47], 0 offen offset:192
    s_nop 1
    v_accvgpr_read_b32 v8, a56
    v_accvgpr_read_b32 v9, a57
    v_accvgpr_read_b32 v10, a58
    v_accvgpr_read_b32 v11, a59
    v_accvgpr_read_b32 v12, a60
    v_accvgpr_read_b32 v13, a61
    v_accvgpr_read_b32 v14, a62
    v_accvgpr_read_b32 v15, a63
    v_mul_f32 v8, v8, v131
    v_mul_f32 v9, v9, v131
    v_mul_f32 v10, v10, v131
    v_mul_f32 v11, v11, v131
    v_mul_f32 v12, v12, v131
    v_mul_f32 v13, v13, v131
    v_mul_f32 v14, v14, v131
    v_mul_f32 v15, v15, v131
    v_cvt_pk_bf16_f32 v16, v8, v9
    v_cvt_pk_bf16_f32 v17, v10, v11
    v_cvt_pk_bf16_f32 v18, v12, v13
    v_cvt_pk_bf16_f32 v19, v14, v15
    s_nop 1
    v_permlane32_swap_b32 v16, v18
    v_permlane32_swap_b32 v17, v19
    buffer_store_dwordx4 v[16:19], v138, s[44:47], 0 offen offset:224
    s_nop 1
    v_mov_b32 v130, v109
    s_nop 1
    v_permlane32_swap_b32 v109, v130
    s_nop 1
    v_add_f32 v130, v130, v109
    v_rcp_f32 v131, v130
    s_nop 0
    v_accvgpr_read_b32 v8, a64
    v_accvgpr_read_b32 v9, a65
    v_accvgpr_read_b32 v10, a66
    v_accvgpr_read_b32 v11, a67
    v_accvgpr_read_b32 v12, a68
    v_accvgpr_read_b32 v13, a69
    v_accvgpr_read_b32 v14, a70
    v_accvgpr_read_b32 v15, a71
    v_mul_f32 v8, v8, v131
    v_mul_f32 v9, v9, v131
    v_mul_f32 v10, v10, v131
    v_mul_f32 v11, v11, v131
    v_mul_f32 v12, v12, v131
    v_mul_f32 v13, v13, v131
    v_mul_f32 v14, v14, v131
    v_mul_f32 v15, v15, v131
    v_cvt_pk_bf16_f32 v16, v8, v9
    v_cvt_pk_bf16_f32 v17, v10, v11
    v_cvt_pk_bf16_f32 v18, v12, v13
    v_cvt_pk_bf16_f32 v19, v14, v15
    s_nop 1
    v_permlane32_swap_b32 v16, v18
    v_permlane32_swap_b32 v17, v19
    buffer_store_dwordx4 v[16:19], v139, s[44:47], 0 offen offset:0
    s_nop 1
    v_accvgpr_read_b32 v8, a72
    v_accvgpr_read_b32 v9, a73
    v_accvgpr_read_b32 v10, a74
    v_accvgpr_read_b32 v11, a75
    v_accvgpr_read_b32 v12, a76
    v_accvgpr_read_b32 v13, a77
    v_accvgpr_read_b32 v14, a78
    v_accvgpr_read_b32 v15, a79
    v_mul_f32 v8, v8, v131
    v_mul_f32 v9, v9, v131
    v_mul_f32 v10, v10, v131
    v_mul_f32 v11, v11, v131
    v_mul_f32 v12, v12, v131
    v_mul_f32 v13, v13, v131
    v_mul_f32 v14, v14, v131
    v_mul_f32 v15, v15, v131
    v_cvt_pk_bf16_f32 v16, v8, v9
    v_cvt_pk_bf16_f32 v17, v10, v11
    v_cvt_pk_bf16_f32 v18, v12, v13
    v_cvt_pk_bf16_f32 v19, v14, v15
    s_nop 1
    v_permlane32_swap_b32 v16, v18
    v_permlane32_swap_b32 v17, v19
    buffer_store_dwordx4 v[16:19], v139, s[44:47], 0 offen offset:32
    s_nop 1
    v_accvgpr_read_b32 v8, a80
    v_accvgpr_read_b32 v9, a81
    v_accvgpr_read_b32 v10, a82
    v_accvgpr_read_b32 v11, a83
    v_accvgpr_read_b32 v12, a84
    v_accvgpr_read_b32 v13, a85
    v_accvgpr_read_b32 v14, a86
    v_accvgpr_read_b32 v15, a87
    v_mul_f32 v8, v8, v131
    v_mul_f32 v9, v9, v131
    v_mul_f32 v10, v10, v131
    v_mul_f32 v11, v11, v131
    v_mul_f32 v12, v12, v131
    v_mul_f32 v13, v13, v131
    v_mul_f32 v14, v14, v131
    v_mul_f32 v15, v15, v131
    v_cvt_pk_bf16_f32 v16, v8, v9
    v_cvt_pk_bf16_f32 v17, v10, v11
    v_cvt_pk_bf16_f32 v18, v12, v13
    v_cvt_pk_bf16_f32 v19, v14, v15
    s_nop 1
    v_permlane32_swap_b32 v16, v18
    v_permlane32_swap_b32 v17, v19
    buffer_store_dwordx4 v[16:19], v139, s[44:47], 0 offen offset:64
    s_nop 1
    v_accvgpr_read_b32 v8, a88
    v_accvgpr_read_b32 v9, a89
    v_accvgpr_read_b32 v10, a90
    v_accvgpr_read_b32 v11, a91
    v_accvgpr_read_b32 v12, a92
    v_accvgpr_read_b32 v13, a93
    v_accvgpr_read_b32 v14, a94
    v_accvgpr_read_b32 v15, a95
    v_mul_f32 v8, v8, v131
    v_mul_f32 v9, v9, v131
    v_mul_f32 v10, v10, v131
    v_mul_f32 v11, v11, v131
    v_mul_f32 v12, v12, v131
    v_mul_f32 v13, v13, v131
    v_mul_f32 v14, v14, v131
    v_mul_f32 v15, v15, v131
    v_cvt_pk_bf16_f32 v16, v8, v9
    v_cvt_pk_bf16_f32 v17, v10, v11
    v_cvt_pk_bf16_f32 v18, v12, v13
    v_cvt_pk_bf16_f32 v19, v14, v15
    s_nop 1
    v_permlane32_swap_b32 v16, v18
    v_permlane32_swap_b32 v17, v19
    buffer_store_dwordx4 v[16:19], v139, s[44:47], 0 offen offset:96
    s_nop 1
    v_accvgpr_read_b32 v8, a96
    v_accvgpr_read_b32 v9, a97
    v_accvgpr_read_b32 v10, a98
    v_accvgpr_read_b32 v11, a99
    v_accvgpr_read_b32 v12, a100
    v_accvgpr_read_b32 v13, a101
    v_accvgpr_read_b32 v14, a102
    v_accvgpr_read_b32 v15, a103
    v_mul_f32 v8, v8, v131
    v_mul_f32 v9, v9, v131
    v_mul_f32 v10, v10, v131
    v_mul_f32 v11, v11, v131
    v_mul_f32 v12, v12, v131
    v_mul_f32 v13, v13, v131
    v_mul_f32 v14, v14, v131
    v_mul_f32 v15, v15, v131
    v_cvt_pk_bf16_f32 v16, v8, v9
    v_cvt_pk_bf16_f32 v17, v10, v11
    v_cvt_pk_bf16_f32 v18, v12, v13
    v_cvt_pk_bf16_f32 v19, v14, v15
    s_nop 1
    v_permlane32_swap_b32 v16, v18
    v_permlane32_swap_b32 v17, v19
    buffer_store_dwordx4 v[16:19], v139, s[44:47], 0 offen offset:128
    s_nop 1
    v_accvgpr_read_b32 v8, a104
    v_accvgpr_read_b32 v9, a105
    v_accvgpr_read_b32 v10, a106
    v_accvgpr_read_b32 v11, a107
    v_accvgpr_read_b32 v12, a108
    v_accvgpr_read_b32 v13, a109
    v_accvgpr_read_b32 v14, a110
    v_accvgpr_read_b32 v15, a111
    v_mul_f32 v8, v8, v131
    v_mul_f32 v9, v9, v131
    v_mul_f32 v10, v10, v131
    v_mul_f32 v11, v11, v131
    v_mul_f32 v12, v12, v131
    v_mul_f32 v13, v13, v131
    v_mul_f32 v14, v14, v131
    v_mul_f32 v15, v15, v131
    v_cvt_pk_bf16_f32 v16, v8, v9
    v_cvt_pk_bf16_f32 v17, v10, v11
    v_cvt_pk_bf16_f32 v18, v12, v13
    v_cvt_pk_bf16_f32 v19, v14, v15
    s_nop 1
    v_permlane32_swap_b32 v16, v18
    v_permlane32_swap_b32 v17, v19
    buffer_store_dwordx4 v[16:19], v139, s[44:47], 0 offen offset:160
    s_nop 1
    v_accvgpr_read_b32 v8, a112
    v_accvgpr_read_b32 v9, a113
    v_accvgpr_read_b32 v10, a114
    v_accvgpr_read_b32 v11, a115
    v_accvgpr_read_b32 v12, a116
    v_accvgpr_read_b32 v13, a117
    v_accvgpr_read_b32 v14, a118
    v_accvgpr_read_b32 v15, a119
    v_mul_f32 v8, v8, v131
    v_mul_f32 v9, v9, v131
    v_mul_f32 v10, v10, v131
    v_mul_f32 v11, v11, v131
    v_mul_f32 v12, v12, v131
    v_mul_f32 v13, v13, v131
    v_mul_f32 v14, v14, v131
    v_mul_f32 v15, v15, v131
    v_cvt_pk_bf16_f32 v16, v8, v9
    v_cvt_pk_bf16_f32 v17, v10, v11
    v_cvt_pk_bf16_f32 v18, v12, v13
    v_cvt_pk_bf16_f32 v19, v14, v15
    s_nop 1
    v_permlane32_swap_b32 v16, v18
    v_permlane32_swap_b32 v17, v19
    buffer_store_dwordx4 v[16:19], v139, s[44:47], 0 offen offset:192
    s_nop 1
    v_accvgpr_read_b32 v8, a120
    v_accvgpr_read_b32 v9, a121
    v_accvgpr_read_b32 v10, a122
    v_accvgpr_read_b32 v11, a123
    v_accvgpr_read_b32 v12, a124
    v_accvgpr_read_b32 v13, a125
    v_accvgpr_read_b32 v14, a126
    v_accvgpr_read_b32 v15, a127
    v_mul_f32 v8, v8, v131
    v_mul_f32 v9, v9, v131
    v_mul_f32 v10, v10, v131
    v_mul_f32 v11, v11, v131
    v_mul_f32 v12, v12, v131
    v_mul_f32 v13, v13, v131
    v_mul_f32 v14, v14, v131
    v_mul_f32 v15, v15, v131
    v_cvt_pk_bf16_f32 v16, v8, v9
    v_cvt_pk_bf16_f32 v17, v10, v11
    v_cvt_pk_bf16_f32 v18, v12, v13
    v_cvt_pk_bf16_f32 v19, v14, v15
    s_nop 1
    v_permlane32_swap_b32 v16, v18
    v_permlane32_swap_b32 v17, v19
    buffer_store_dwordx4 v[16:19], v139, s[44:47], 0 offen offset:224
    s_nop 1
    s_branch at_fin
at_slow0:
    s_nop 15
    v_max3_f32 v130, v0, v1, v2
    v_max3_f32 v130, v130, v3, v4
    v_max3_f32 v130, v130, v5, v6
    v_max3_f32 v130, v130, v7, v8
    v_max3_f32 v130, v130, v9, v10
    v_max3_f32 v130, v130, v11, v12
    v_max3_f32 v130, v130, v13, v14
    v_max_f32 v130, v130, v15
    v_mov_b32 v131, v130
    s_nop 1
    v_permlane32_swap_b32 v130, v131
    s_nop 1
    v_max_f32 v130, v130, v131
    v_max_f32 v130, 0, v130
    v_sub_f32 v131, 0, v130
    v_exp_f32 v131, v131
    v_sub_f32 v0, v0, v130
    v_sub_f32 v32, v32, v130
    v_sub_f32 v144, v144, v130
    v_sub_f32 v1, v1, v130
    v_sub_f32 v33, v33, v130
    v_sub_f32 v145, v145, v130
    v_sub_f32 v2, v2, v130
    v_sub_f32 v34, v34, v130
    v_sub_f32 v146, v146, v130
    v_sub_f32 v3, v3, v130
    v_sub_f32 v35, v35, v130
    v_sub_f32 v147, v147, v130
    v_sub_f32 v4, v4, v130
    v_sub_f32 v36, v36, v130
    v_sub_f32 v148, v148, v130
    v_sub_f32 v5, v5, v130
    v_sub_f32 v37, v37, v130
    v_sub_f32 v149, v149, v130
    v_sub_f32 v6, v6, v130
    v_sub_f32 v38, v38, v130
    v_sub_f32 v150, v150, v130
    v_sub_f32 v7, v7, v130
    v_sub_f32 v39, v39, v130
    v_sub_f32 v151, v151, v130
    v_sub_f32 v8, v8, v130
    v_sub_f32 v40, v40, v130
    v_sub_f32 v152, v152, v130
    v_sub_f32 v9, v9, v130
    v_sub_f32 v41, v41, v130
    v_sub_f32 v153, v153, v130
    v_sub_f32 v10, v10, v130
    v_sub_f32 v42, v42, v130
    v_sub_f32 v154, v154, v130
    v_sub_f32 v11, v11, v130
    v_sub_f32 v43, v43, v130
    v_sub_f32 v155, v155, v130
    v_sub_f32 v12, v12, v130
    v_sub_f32 v44, v44, v130
    v_sub_f32 v156, v156, v130
    v_sub_f32 v13, v13, v130
    v_sub_f32 v45, v45, v130
    v_sub_f32 v157, v157, v130
    v_sub_f32 v14, v14, v130
    v_sub_f32 v46, v46, v130
    v_sub_f32 v158, v158, v130
    v_sub_f32 v15, v15, v130
    v_sub_f32 v47, v47, v130
    v_sub_f32 v159, v159, v130
    v_mul_f32 v108, v108, v131
    v_accvgpr_read_b32 v132, a0
    v_accvgpr_read_b32 v133, a1
    v_accvgpr_read_b32 v134, a2
    v_accvgpr_read_b32 v135, a3
    v_mul_f32 v132, v132, v131
    v_mul_f32 v133, v133, v131
    v_mul_f32 v134, v134, v131
    v_mul_f32 v135, v135, v131
    v_accvgpr_write_b32 a0, v132
    v_accvgpr_write_b32 a1, v133
    v_accvgpr_write_b32 a2, v134
    v_accvgpr_write_b32 a3, v135
    v_accvgpr_read_b32 v132, a4
    v_accvgpr_read_b32 v133, a5
    v_accvgpr_read_b32 v134, a6
    v_accvgpr_read_b32 v135, a7
    v_mul_f32 v132, v132, v131
    v_mul_f32 v133, v133, v131
    v_mul_f32 v134, v134, v131
    v_mul_f32 v135, v135, v131
    v_accvgpr_write_b32 a4, v132
    v_accvgpr_write_b32 a5, v133
    v_accvgpr_write_b32 a6, v134
    v_accvgpr_write_b32 a7, v135
    v_accvgpr_read_b32 v132, a8
    v_accvgpr_read_b32 v133, a9
    v_accvgpr_read_b32 v134, a10
    v_accvgpr_read_b32 v135, a11
    v_mul_f32 v132, v132, v131
    v_mul_f32 v133, v133, v131
    v_mul_f32 v134, v134, v131
    v_mul_f32 v135, v135, v131
    v_accvgpr_write_b32 a8, v132
    v_accvgpr_write_b32 a9, v133
    v_accvgpr_write_b32 a10, v134
    v_accvgpr_write_b32 a11, v135
    v_accvgpr_read_b32 v132, a12
    v_accvgpr_read_b32 v133, a13
    v_accvgpr_read_b32 v134, a14
    v_accvgpr_read_b32 v135, a15
    v_mul_f32 v132, v132, v131
    v_mul_f32 v133, v133, v131
    v_mul_f32 v134, v134, v131
    v_mul_f32 v135, v135, v131
    v_accvgpr_write_b32 a12, v132
    v_accvgpr_write_b32 a13, v133
    v_accvgpr_write_b32 a14, v134
    v_accvgpr_write_b32 a15, v135
    v_accvgpr_read_b32 v132, a16
    v_accvgpr_read_b32 v133, a17
    v_accvgpr_read_b32 v134, a18
    v_accvgpr_read_b32 v135, a19
    v_mul_f32 v132, v132, v131
    v_mul_f32 v133, v133, v131
    v_mul_f32 v134, v134, v131
    v_mul_f32 v135, v135, v131
    v_accvgpr_write_b32 a16, v132
    v_accvgpr_write_b32 a17, v133
    v_accvgpr_write_b32 a18, v134
    v_accvgpr_write_b32 a19, v135
    v_accvgpr_read_b32 v132, a20
    v_accvgpr_read_b32 v133, a21
    v_accvgpr_read_b32 v134, a22
    v_accvgpr_read_b32 v135, a23
    v_mul_f32 v132, v132, v131
    v_mul_f32 v133, v133, v131
    v_mul_f32 v134, v134, v131
    v_mul_f32 v135, v135, v131
    v_accvgpr_write_b32 a20, v132
    v_accvgpr_write_b32 a21, v133
    v_accvgpr_write_b32 a22, v134
    v_accvgpr_write_b32 a23, v135
    v_accvgpr_read_b32 v132, a24
    v_accvgpr_read_b32 v133, a25
    v_accvgpr_read_b32 v134, a26
    v_accvgpr_read_b32 v135, a27
    v_mul_f32 v132, v132, v131
    v_mul_f32 v133, v133, v131
    v_mul_f32 v134, v134, v131
    v_mul_f32 v135, v135, v131
    v_accvgpr_write_b32 a24, v132
    v_accvgpr_write_b32 a25, v133
    v_accvgpr_write_b32 a26, v134
    v_accvgpr_write_b32 a27, v135
    v_accvgpr_read_b32 v132, a28
    v_accvgpr_read_b32 v133, a29
    v_accvgpr_read_b32 v134, a30
    v_accvgpr_read_b32 v135, a31
    v_mul_f32 v132, v132, v131
    v_mul_f32 v133, v133, v131
    v_mul_f32 v134, v134, v131
    v_mul_f32 v135, v135, v131
    v_accvgpr_write_b32 a28, v132
    v_accvgpr_write_b32 a29, v133
    v_accvgpr_write_b32 a30, v134
    v_accvgpr_write_b32 a31, v135
    v_accvgpr_read_b32 v132, a32
    v_accvgpr_read_b32 v133, a33
    v_accvgpr_read_b32 v134, a34
    v_accvgpr_read_b32 v135, a35
    v_mul_f32 v132, v132, v131
    v_mul_f32 v133, v133, v131
    v_mul_f32 v134, v134, v131
    v_mul_f32 v135, v135, v131
    v_accvgpr_write_b32 a32, v132
    v_accvgpr_write_b32 a33, v133
    v_accvgpr_write_b32 a34, v134
    v_accvgpr_write_b32 a35, v135
    v_accvgpr_read_b32 v132, a36
    v_accvgpr_read_b32 v133, a37
    v_accvgpr_read_b32 v134, a38
    v_accvgpr_read_b32 v135, a39
    v_mul_f32 v132, v132, v131
    v_mul_f32 v133, v133, v131
    v_mul_f32 v134, v134, v131
    v_mul_f32 v135, v135, v131
    v_accvgpr_write_b32 a36, v132
    v_accvgpr_write_b32 a37, v133
    v_accvgpr_write_b32 a38, v134
    v_accvgpr_write_b32 a39, v135
    v_accvgpr_read_b32 v132, a40
    v_accvgpr_read_b32 v133, a41
    v_accvgpr_read_b32 v134, a42
    v_accvgpr_read_b32 v135, a43
    v_mul_f32 v132, v132, v131
    v_mul_f32 v133, v133, v131
    v_mul_f32 v134, v134, v131
    v_mul_f32 v135, v135, v131
    v_accvgpr_write_b32 a40, v132
    v_accvgpr_write_b32 a41, v133
    v_accvgpr_write_b32 a42, v134
    v_accvgpr_write_b32 a43, v135
    v_accvgpr_read_b32 v132, a44
    v_accvgpr_read_b32 v133, a45
    v_accvgpr_read_b32 v134, a46
    v_accvgpr_read_b32 v135, a47
    v_mul_f32 v132, v132, v131
    v_mul_f32 v133, v133, v131
    v_mul_f32 v134, v134, v131
    v_mul_f32 v135, v135, v131
    v_accvgpr_write_b32 a44, v132
    v_accvgpr_write_b32 a45, v133
    v_accvgpr_write_b32 a46, v134
    v_accvgpr_write_b32 a47, v135
    v_accvgpr_read_b32 v132, a48
    v_accvgpr_read_b32 v133, a49
    v_accvgpr_read_b32 v134, a50
    v_accvgpr_read_b32 v135, a51
    v_mul_f32 v132, v132, v131
    v_mul_f32 v133, v133, v131
    v_mul_f32 v134, v134, v131
    v_mul_f32 v135, v135, v131
    v_accvgpr_write_b32 a48, v132
    v_accvgpr_write_b32 a49, v133
    v_accvgpr_write_b32 a50, v134
    v_accvgpr_write_b32 a51, v135
    v_accvgpr_read_b32 v132, a52
    v_accvgpr_read_b32 v133, a53
    v_accvgpr_read_b32 v134, a54
    v_accvgpr_read_b32 v135, a55
    v_mul_f32 v132, v132, v131
    v_mul_f32 v133, v133, v131
    v_mul_f32 v134, v134, v131
    v_mul_f32 v135, v135, v131
    v_accvgpr_write_b32 a52, v132
    v_accvgpr_write_b32 a53, v133
    v_accvgpr_write_b32 a54, v134
    v_accvgpr_write_b32 a55, v135
    v_accvgpr_read_b32 v132, a56
    v_accvgpr_read_b32 v133, a57
    v_accvgpr_read_b32 v134, a58
    v_accvgpr_read_b32 v135, a59
    v_mul_f32 v132, v132, v131
    v_mul_f32 v133, v133, v131
    v_mul_f32 v134, v134, v131
    v_mul_f32 v135, v135, v131
    v_accvgpr_write_b32 a56, v132
    v_accvgpr_write_b32 a57, v133
    v_accvgpr_write_b32 a58, v134
    v_accvgpr_write_b32 a59, v135
    v_accvgpr_read_b32 v132, a60
    v_accvgpr_read_b32 v133, a61
    v_accvgpr_read_b32 v134, a62
    v_accvgpr_read_b32 v135, a63
    v_mul_f32 v132, v132, v131
    v_mul_f32 v133, v133, v131
    v_mul_f32 v134, v134, v131
    v_mul_f32 v135, v135, v131
    v_accvgpr_write_b32 a60, v132
    v_accvgpr_write_b32 a61, v133
    v_accvgpr_write_b32 a62, v134
    v_accvgpr_write_b32 a63, v135
    v_max3_f32 v130, v16, v17, v18
    v_max3_f32 v130, v130, v19, v20
    v_max3_f32 v130, v130, v21, v22
    v_max3_f32 v130, v130, v23, v24
    v_max3_f32 v130, v130, v25, v26
    v_max3_f32 v130, v130, v27, v28
    v_max3_f32 v130, v130, v29, v30
    v_max_f32 v130, v130, v31
    v_mov_b32 v131, v130
    s_nop 1
    v_permlane32_swap_b32 v130, v131
    s_nop 1
    v_max_f32 v130, v130, v131
    v_max_f32 v130, 0, v130
    v_sub_f32 v131, 0, v130
    v_exp_f32 v131, v131
    v_sub_f32 v16, v16, v130
    v_sub_f32 v48, v48, v130
    v_sub_f32 v160, v160, v130
    v_sub_f32 v17, v17, v130
    v_sub_f32 v49, v49, v130
    v_sub_f32 v161, v161, v130
    v_sub_f32 v18, v18, v130
    v_sub_f32 v50, v50, v130
    v_sub_f32 v162, v162, v130
    v_sub_f32 v19, v19, v130
    v_sub_f32 v51, v51, v130
    v_sub_f32 v163, v163, v130
    v_sub_f32 v20, v20, v130
    v_sub_f32 v52, v52, v130
    v_sub_f32 v164, v164, v130
    v_sub_f32 v21, v21, v130
    v_sub_f32 v53, v53, v130
    v_sub_f32 v165, v165, v130
    v_sub_f32 v22, v22, v130
    v_sub_f32 v54, v54, v130
    v_sub_f32 v166, v166, v130
    v_sub_f32 v23, v23, v130
    v_sub_f32 v55, v55, v130
    v_sub_f32 v167, v167, v130
    v_sub_f32 v24, v24, v130
    v_sub_f32 v56, v56, v130
    v_sub_f32 v168, v168, v130
    v_sub_f32 v25, v25, v130
    v_sub_f32 v57, v57, v130
    v_sub_f32 v169, v169, v130
    v_sub_f32 v26, v26, v130
    v_sub_f32 v58, v58, v130
    v_sub_f32 v170, v170, v130
    v_sub_f32 v27, v27, v130
    v_sub_f32 v59, v59, v130
    v_sub_f32 v171, v171, v130
    v_sub_f32 v28, v28, v130
    v_sub_f32 v60, v60, v130
    v_sub_f32 v172, v172, v130
    v_sub_f32 v29, v29, v130
    v_sub_f32 v61, v61, v130
    v_sub_f32 v173, v173, v130
    v_sub_f32 v30, v30, v130
    v_sub_f32 v62, v62, v130
    v_sub_f32 v174, v174, v130
    v_sub_f32 v31, v31, v130
    v_sub_f32 v63, v63, v130
    v_sub_f32 v175, v175, v130
    v_mul_f32 v109, v109, v131
    v_accvgpr_read_b32 v132, a64
    v_accvgpr_read_b32 v133, a65
    v_accvgpr_read_b32 v134, a66
    v_accvgpr_read_b32 v135, a67
    v_mul_f32 v132, v132, v131
    v_mul_f32 v133, v133, v131
    v_mul_f32 v134, v134, v131
    v_mul_f32 v135, v135, v131
    v_accvgpr_write_b32 a64, v132
    v_accvgpr_write_b32 a65, v133
    v_accvgpr_write_b32 a66, v134
    v_accvgpr_write_b32 a67, v135
    v_accvgpr_read_b32 v132, a68
    v_accvgpr_read_b32 v133, a69
    v_accvgpr_read_b32 v134, a70
    v_accvgpr_read_b32 v135, a71
    v_mul_f32 v132, v132, v131
    v_mul_f32 v133, v133, v131
    v_mul_f32 v134, v134, v131
    v_mul_f32 v135, v135, v131
    v_accvgpr_write_b32 a68, v132
    v_accvgpr_write_b32 a69, v133
    v_accvgpr_write_b32 a70, v134
    v_accvgpr_write_b32 a71, v135
    v_accvgpr_read_b32 v132, a72
    v_accvgpr_read_b32 v133, a73
    v_accvgpr_read_b32 v134, a74
    v_accvgpr_read_b32 v135, a75
    v_mul_f32 v132, v132, v131
    v_mul_f32 v133, v133, v131
    v_mul_f32 v134, v134, v131
    v_mul_f32 v135, v135, v131
    v_accvgpr_write_b32 a72, v132
    v_accvgpr_write_b32 a73, v133
    v_accvgpr_write_b32 a74, v134
    v_accvgpr_write_b32 a75, v135
    v_accvgpr_read_b32 v132, a76
    v_accvgpr_read_b32 v133, a77
    v_accvgpr_read_b32 v134, a78
    v_accvgpr_read_b32 v135, a79
    v_mul_f32 v132, v132, v131
    v_mul_f32 v133, v133, v131
    v_mul_f32 v134, v134, v131
    v_mul_f32 v135, v135, v131
    v_accvgpr_write_b32 a76, v132
    v_accvgpr_write_b32 a77, v133
    v_accvgpr_write_b32 a78, v134
    v_accvgpr_write_b32 a79, v135
    v_accvgpr_read_b32 v132, a80
    v_accvgpr_read_b32 v133, a81
    v_accvgpr_read_b32 v134, a82
    v_accvgpr_read_b32 v135, a83
    v_mul_f32 v132, v132, v131
    v_mul_f32 v133, v133, v131
    v_mul_f32 v134, v134, v131
    v_mul_f32 v135, v135, v131
    v_accvgpr_write_b32 a80, v132
    v_accvgpr_write_b32 a81, v133
    v_accvgpr_write_b32 a82, v134
    v_accvgpr_write_b32 a83, v135
    v_accvgpr_read_b32 v132, a84
    v_accvgpr_read_b32 v133, a85
    v_accvgpr_read_b32 v134, a86
    v_accvgpr_read_b32 v135, a87
    v_mul_f32 v132, v132, v131
    v_mul_f32 v133, v133, v131
    v_mul_f32 v134, v134, v131
    v_mul_f32 v135, v135, v131
    v_accvgpr_write_b32 a84, v132
    v_accvgpr_write_b32 a85, v133
    v_accvgpr_write_b32 a86, v134
    v_accvgpr_write_b32 a87, v135
    v_accvgpr_read_b32 v132, a88
    v_accvgpr_read_b32 v133, a89
    v_accvgpr_read_b32 v134, a90
    v_accvgpr_read_b32 v135, a91
    v_mul_f32 v132, v132, v131
    v_mul_f32 v133, v133, v131
    v_mul_f32 v134, v134, v131
    v_mul_f32 v135, v135, v131
    v_accvgpr_write_b32 a88, v132
    v_accvgpr_write_b32 a89, v133
    v_accvgpr_write_b32 a90, v134
    v_accvgpr_write_b32 a91, v135
    v_accvgpr_read_b32 v132, a92
    v_accvgpr_read_b32 v133, a93
    v_accvgpr_read_b32 v134, a94
    v_accvgpr_read_b32 v135, a95
    v_mul_f32 v132, v132, v131
    v_mul_f32 v133, v133, v131
    v_mul_f32 v134, v134, v131
    v_mul_f32 v135, v135, v131
    v_accvgpr_write_b32 a92, v132
    v_accvgpr_write_b32 a93, v133
    v_accvgpr_write_b32 a94, v134
    v_accvgpr_write_b32 a95, v135
    v_accvgpr_read_b32 v132, a96
    v_accvgpr_read_b32 v133, a97
    v_accvgpr_read_b32 v134, a98
    v_accvgpr_read_b32 v135, a99
    v_mul_f32 v132, v132, v131
    v_mul_f32 v133, v133, v131
    v_mul_f32 v134, v134, v131
    v_mul_f32 v135, v135, v131
    v_accvgpr_write_b32 a96, v132
    v_accvgpr_write_b32 a97, v133
    v_accvgpr_write_b32 a98, v134
    v_accvgpr_write_b32 a99, v135
    v_accvgpr_read_b32 v132, a100
    v_accvgpr_read_b32 v133, a101
    v_accvgpr_read_b32 v134, a102
    v_accvgpr_read_b32 v135, a103
    v_mul_f32 v132, v132, v131
    v_mul_f32 v133, v133, v131
    v_mul_f32 v134, v134, v131
    v_mul_f32 v135, v135, v131
    v_accvgpr_write_b32 a100, v132
    v_accvgpr_write_b32 a101, v133
    v_accvgpr_write_b32 a102, v134
    v_accvgpr_write_b32 a103, v135
    v_accvgpr_read_b32 v132, a104
    v_accvgpr_read_b32 v133, a105
    v_accvgpr_read_b32 v134, a106
    v_accvgpr_read_b32 v135, a107
    v_mul_f32 v132, v132, v131
    v_mul_f32 v133, v133, v131
    v_mul_f32 v134, v134, v131
    v_mul_f32 v135, v135, v131
    v_accvgpr_write_b32 a104, v132
    v_accvgpr_write_b32 a105, v133
    v_accvgpr_write_b32 a106, v134
    v_accvgpr_write_b32 a107, v135
    v_accvgpr_read_b32 v132, a108
    v_accvgpr_read_b32 v133, a109
    v_accvgpr_read_b32 v134, a110
    v_accvgpr_read_b32 v135, a111
    v_mul_f32 v132, v132, v131
    v_mul_f32 v133, v133, v131
    v_mul_f32 v134, v134, v131
    v_mul_f32 v135, v135, v131
    v_accvgpr_write_b32 a108, v132
    v_accvgpr_write_b32 a109, v133
    v_accvgpr_write_b32 a110, v134
    v_accvgpr_write_b32 a111, v135
    v_accvgpr_read_b32 v132, a112
    v_accvgpr_read_b32 v133, a113
    v_accvgpr_read_b32 v134, a114
    v_accvgpr_read_b32 v135, a115
    v_mul_f32 v132, v132, v131
    v_mul_f32 v133, v133, v131
    v_mul_f32 v134, v134, v131
    v_mul_f32 v135, v135, v131
    v_accvgpr_write_b32 a112, v132
    v_accvgpr_write_b32 a113, v133
    v_accvgpr_write_b32 a114, v134
    v_accvgpr_write_b32 a115, v135
    v_accvgpr_read_b32 v132, a116
    v_accvgpr_read_b32 v133, a117
    v_accvgpr_read_b32 v134, a118
    v_accvgpr_read_b32 v135, a119
    v_mul_f32 v132, v132, v131
    v_mul_f32 v133, v133, v131
    v_mul_f32 v134, v134, v131
    v_mul_f32 v135, v135, v131
    v_accvgpr_write_b32 a116, v132
    v_accvgpr_write_b32 a117, v133
    v_accvgpr_write_b32 a118, v134
    v_accvgpr_write_b32 a119, v135
    v_accvgpr_read_b32 v132, a120
    v_accvgpr_read_b32 v133, a121
    v_accvgpr_read_b32 v134, a122
    v_accvgpr_read_b32 v135, a123
    v_mul_f32 v132, v132, v131
    v_mul_f32 v133, v133, v131
    v_mul_f32 v134, v134, v131
    v_mul_f32 v135, v135, v131
    v_accvgpr_write_b32 a120, v132
    v_accvgpr_write_b32 a121, v133
    v_accvgpr_write_b32 a122, v134
    v_accvgpr_write_b32 a123, v135
    v_accvgpr_read_b32 v132, a124
    v_accvgpr_read_b32 v133, a125
    v_accvgpr_read_b32 v134, a126
    v_accvgpr_read_b32 v135, a127
    v_mul_f32 v132, v132, v131
    v_mul_f32 v133, v133, v131
    v_mul_f32 v134, v134, v131
    v_mul_f32 v135, v135, v131
    v_accvgpr_write_b32 a124, v132
    v_accvgpr_write_b32 a125, v133
    v_accvgpr_write_b32 a126, v134
    v_accvgpr_write_b32 a127, v135
    v_exp_f32 v96, v0
    v_exp_f32 v97, v1
    v_exp_f32 v98, v2
    v_exp_f32 v99, v3
    v_exp_f32 v100, v4
    v_exp_f32 v101, v5
    v_mov_b32 v104, v96
    v_mov_b32 v105, v97
    v_cvt_pk_bf16_f32 v64, v96, v97
    v_exp_f32 v102, v6
    v_exp_f32 v103, v7
    v_add_f32 v104, v104, v98
    v_add_f32 v105, v105, v99
    v_cvt_pk_bf16_f32 v65, v98, v99
    v_exp_f32 v96, v8
    v_exp_f32 v97, v9
    v_add_f32 v104, v104, v100
    v_add_f32 v105, v105, v101
    v_cvt_pk_bf16_f32 v66, v100, v101
    v_exp_f32 v98, v10
    v_exp_f32 v99, v11
    v_add_f32 v104, v104, v102
    v_add_f32 v105, v105, v103
    v_cvt_pk_bf16_f32 v67, v102, v103
    v_exp_f32 v100, v12
    v_exp_f32 v101, v13
    v_add_f32 v104, v104, v96
    v_add_f32 v105, v105, v97
    v_cvt_pk_bf16_f32 v68, v96, v97
    v_exp_f32 v102, v14
    v_exp_f32 v103, v15
    v_add_f32 v104, v104, v98
    v_add_f32 v105, v105, v99
    v_cvt_pk_bf16_f32 v69, v98, v99
    v_exp_f32 v96, v16
    v_exp_f32 v97, v17
    v_add_f32 v104, v104, v100
    v_add_f32 v105, v105, v101
    v_cvt_pk_bf16_f32 v70, v100, v101
    v_exp_f32 v98, v18
    v_exp_f32 v99, v19
    v_add_f32 v104, v104, v102
    v_add_f32 v105, v105, v103
    v_cvt_pk_bf16_f32 v71, v102, v103
    v_exp_f32 v100, v20
    v_exp_f32 v101, v21
    v_mov_b32 v106, v96
    v_mov_b32 v107, v97
    v_cvt_pk_bf16_f32 v72, v96, v97
    v_exp_f32 v102, v22
    v_exp_f32 v103, v23
    v_add_f32 v106, v106, v98
    v_add_f32 v107, v107, v99
    v_cvt_pk_bf16_f32 v73, v98, v99
    v_exp_f32 v96, v24
    v_exp_f32 v97, v25
    v_add_f32 v106, v106, v100
    v_add_f32 v107, v107, v101
    v_cvt_pk_bf16_f32 v74, v100, v101
    v_exp_f32 v98, v26
    v_exp_f32 v99, v27
    v_add_f32 v106, v106, v102
    v_add_f32 v107, v107, v103
    v_cvt_pk_bf16_f32 v75, v102, v103
    v_exp_f32 v100, v28
    v_exp_f32 v101, v29
    v_add_f32 v106, v106, v96
    v_add_f32 v107, v107, v97
    v_cvt_pk_bf16_f32 v76, v96, v97
    v_exp_f32 v102, v30
    v_exp_f32 v103, v31
    v_add_f32 v106, v106, v98
    v_add_f32 v107, v107, v99
    v_cvt_pk_bf16_f32 v77, v98, v99
    v_add_f32 v106, v106, v100
    v_add_f32 v107, v107, v101
    v_cvt_pk_bf16_f32 v78, v100, v101
    v_add_f32 v106, v106, v102
    v_add_f32 v107, v107, v103
    v_cvt_pk_bf16_f32 v79, v102, v103
    v_add_f32 v104, v104, v105
    v_add_f32 v106, v106, v107
    s_nop 1
    s_branch at_back0
at_slow1:
    s_nop 15
    v_max3_f32 v130, v32, v33, v34
    v_max3_f32 v130, v130, v35, v36
    v_max3_f32 v130, v130, v37, v38
    v_max3_f32 v130, v130, v39, v40
    v_max3_f32 v130, v130, v41, v42
    v_max3_f32 v130, v130, v43, v44
    v_max3_f32 v130, v130, v45, v46
    v_max_f32 v130, v130, v47
    v_mov_b32 v131, v130
    s_nop 1
    v_permlane32_swap_b32 v130, v131
    s_nop 1
    v_max_f32 v130, v130, v131
    v_max_f32 v130, 0, v130
    v_sub_f32 v131, 0, v130
    v_exp_f32 v131, v131
    v_sub_f32 v32, v32, v130
    v_sub_f32 v0, v0, v130
    v_sub_f32 v144, v144, v130
    v_sub_f32 v33, v33, v130
    v_sub_f32 v1, v1, v130
    v_sub_f32 v145, v145, v130
    v_sub_f32 v34, v34, v130
    v_sub_f32 v2, v2, v130
    v_sub_f32 v146, v146, v130
    v_sub_f32 v35, v35, v130
    v_sub_f32 v3, v3, v130
    v_sub_f32 v147, v147, v130
    v_sub_f32 v36, v36, v130
    v_sub_f32 v4, v4, v130
    v_sub_f32 v148, v148, v130
    v_sub_f32 v37, v37, v130
    v_sub_f32 v5, v5, v130
    v_sub_f32 v149, v149, v130
    v_sub_f32 v38, v38, v130
    v_sub_f32 v6, v6, v130
    v_sub_f32 v150, v150, v130
    v_sub_f32 v39, v39, v130
    v_sub_f32 v7, v7, v130
    v_sub_f32 v151, v151, v130
    v_sub_f32 v40, v40, v130
    v_sub_f32 v8, v8, v130
    v_sub_f32 v152, v152, v130
    v_sub_f32 v41, v41, v130
    v_sub_f32 v9, v9, v130
    v_sub_f32 v153, v153, v130
    v_sub_f32 v42, v42, v130
    v_sub_f32 v10, v10, v130
    v_sub_f32 v154, v154, v130
    v_sub_f32 v43, v43, v130
    v_sub_f32 v11, v11, v130
    v_sub_f32 v155, v155, v130
    v_sub_f32 v44, v44, v130
    v_sub_f32 v12, v12, v130
    v_sub_f32 v156, v156, v130
    v_sub_f32 v45, v45, v130
    v_sub_f32 v13, v13, v130
    v_sub_f32 v157, v157, v130
    v_sub_f32 v46, v46, v130
    v_sub_f32 v14, v14, v130
    v_sub_f32 v158, v158, v130
    v_sub_f32 v47, v47, v130
    v_sub_f32 v15, v15, v130
    v_sub_f32 v159, v159, v130
    v_mul_f32 v108, v108, v131
    v_accvgpr_read_b32 v132, a0
    v_accvgpr_read_b32 v133, a1
    v_accvgpr_read_b32 v134, a2
    v_accvgpr_read_b32 v135, a3
    v_mul_f32 v132, v132, v131
    v_mul_f32 v133, v133, v131
    v_mul_f32 v134, v134, v131
    v_mul_f32 v135, v135, v131
    v_accvgpr_write_b32 a0, v132
    v_accvgpr_write_b32 a1, v133
    v_accvgpr_write_b32 a2, v134
    v_accvgpr_write_b32 a3, v135
    v_accvgpr_read_b32 v132, a4
    v_accvgpr_read_b32 v133, a5
    v_accvgpr_read_b32 v134, a6
    v_accvgpr_read_b32 v135, a7
    v_mul_f32 v132, v132, v131
    v_mul_f32 v133, v133, v131
    v_mul_f32 v134, v134, v131
    v_mul_f32 v135, v135, v131
    v_accvgpr_write_b32 a4, v132
    v_accvgpr_write_b32 a5, v133
    v_accvgpr_write_b32 a6, v134
    v_accvgpr_write_b32 a7, v135
    v_accvgpr_read_b32 v132, a8
    v_accvgpr_read_b32 v133, a9
    v_accvgpr_read_b32 v134, a10
    v_accvgpr_read_b32 v135, a11
    v_mul_f32 v132, v132, v131
    v_mul_f32 v133, v133, v131
    v_mul_f32 v134, v134, v131
    v_mul_f32 v135, v135, v131
    v_accvgpr_write_b32 a8, v132
    v_accvgpr_write_b32 a9, v133
    v_accvgpr_write_b32 a10, v134
    v_accvgpr_write_b32 a11, v135
    v_accvgpr_read_b32 v132, a12
    v_accvgpr_read_b32 v133, a13
    v_accvgpr_read_b32 v134, a14
    v_accvgpr_read_b32 v135, a15
    v_mul_f32 v132, v132, v131
    v_mul_f32 v133, v133, v131
    v_mul_f32 v134, v134, v131
    v_mul_f32 v135, v135, v131
    v_accvgpr_write_b32 a12, v132
    v_accvgpr_write_b32 a13, v133
    v_accvgpr_write_b32 a14, v134
    v_accvgpr_write_b32 a15, v135
    v_accvgpr_read_b32 v132, a16
    v_accvgpr_read_b32 v133, a17
    v_accvgpr_read_b32 v134, a18
    v_accvgpr_read_b32 v135, a19
    v_mul_f32 v132, v132, v131
    v_mul_f32 v133, v133, v131
    v_mul_f32 v134, v134, v131
    v_mul_f32 v135, v135, v131
    v_accvgpr_write_b32 a16, v132
    v_accvgpr_write_b32 a17, v133
    v_accvgpr_write_b32 a18, v134
    v_accvgpr_write_b32 a19, v135
    v_accvgpr_read_b32 v132, a20
    v_accvgpr_read_b32 v133, a21
    v_accvgpr_read_b32 v134, a22
    v_accvgpr_read_b32 v135, a23
    v_mul_f32 v132, v132, v131
    v_mul_f32 v133, v133, v131
    v_mul_f32 v134, v134, v131
    v_mul_f32 v135, v135, v131
    v_accvgpr_write_b32 a20, v132
    v_accvgpr_write_b32 a21, v133
    v_accvgpr_write_b32 a22, v134
    v_accvgpr_write_b32 a23, v135
    v_accvgpr_read_b32 v132, a24
    v_accvgpr_read_b32 v133, a25
    v_accvgpr_read_b32 v134, a26
    v_accvgpr_read_b32 v135, a27
    v_mul_f32 v132, v132, v131
    v_mul_f32 v133, v133, v131
    v_mul_f32 v134, v134, v131
    v_mul_f32 v135, v135, v131
    v_accvgpr_write_b32 a24, v132
    v_accvgpr_write_b32 a25, v133
    v_accvgpr_write_b32 a26, v134
    v_accvgpr_write_b32 a27, v135
    v_accvgpr_read_b32 v132, a28
    v_accvgpr_read_b32 v133, a29
    v_accvgpr_read_b32 v134, a30
    v_accvgpr_read_b32 v135, a31
    v_mul_f32 v132, v132, v131
    v_mul_f32 v133, v133, v131
    v_mul_f32 v134, v134, v131
    v_mul_f32 v135, v135, v131
    v_accvgpr_write_b32 a28, v132
    v_accvgpr_write_b32 a29, v133
    v_accvgpr_write_b32 a30, v134
    v_accvgpr_write_b32 a31, v135
    v_accvgpr_read_b32 v132, a32
    v_accvgpr_read_b32 v133, a33
    v_accvgpr_read_b32 v134, a34
    v_accvgpr_read_b32 v135, a35
    v_mul_f32 v132, v132, v131
    v_mul_f32 v133, v133, v131
    v_mul_f32 v134, v134, v131
    v_mul_f32 v135, v135, v131
    v_accvgpr_write_b32 a32, v132
    v_accvgpr_write_b32 a33, v133
    v_accvgpr_write_b32 a34, v134
    v_accvgpr_write_b32 a35, v135
    v_accvgpr_read_b32 v132, a36
    v_accvgpr_read_b32 v133, a37
    v_accvgpr_read_b32 v134, a38
    v_accvgpr_read_b32 v135, a39
    v_mul_f32 v132, v132, v131
    v_mul_f32 v133, v133, v131
    v_mul_f32 v134, v134, v131
    v_mul_f32 v135, v135, v131
    v_accvgpr_write_b32 a36, v132
    v_accvgpr_write_b32 a37, v133
    v_accvgpr_write_b32 a38, v134
    v_accvgpr_write_b32 a39, v135
    v_accvgpr_read_b32 v132, a40
    v_accvgpr_read_b32 v133, a41
    v_accvgpr_read_b32 v134, a42
    v_accvgpr_read_b32 v135, a43
    v_mul_f32 v132, v132, v131
    v_mul_f32 v133, v133, v131
    v_mul_f32 v134, v134, v131
    v_mul_f32 v135, v135, v131
    v_accvgpr_write_b32 a40, v132
    v_accvgpr_write_b32 a41, v133
    v_accvgpr_write_b32 a42, v134
    v_accvgpr_write_b32 a43, v135
    v_accvgpr_read_b32 v132, a44
    v_accvgpr_read_b32 v133, a45
    v_accvgpr_read_b32 v134, a46
    v_accvgpr_read_b32 v135, a47
    v_mul_f32 v132, v132, v131
    v_mul_f32 v133, v133, v131
    v_mul_f32 v134, v134, v131
    v_mul_f32 v135, v135, v131
    v_accvgpr_write_b32 a44, v132
    v_accvgpr_write_b32 a45, v133
    v_accvgpr_write_b32 a46, v134
    v_accvgpr_write_b32 a47, v135
    v_accvgpr_read_b32 v132, a48
    v_accvgpr_read_b32 v133, a49
    v_accvgpr_read_b32 v134, a50
    v_accvgpr_read_b32 v135, a51
    v_mul_f32 v132, v132, v131
    v_mul_f32 v133, v133, v131
    v_mul_f32 v134, v134, v131
    v_mul_f32 v135, v135, v131
    v_accvgpr_write_b32 a48, v132
    v_accvgpr_write_b32 a49, v133
    v_accvgpr_write_b32 a50, v134
    v_accvgpr_write_b32 a51, v135
    v_accvgpr_read_b32 v132, a52
    v_accvgpr_read_b32 v133, a53
    v_accvgpr_read_b32 v134, a54
    v_accvgpr_read_b32 v135, a55
    v_mul_f32 v132, v132, v131
    v_mul_f32 v133, v133, v131
    v_mul_f32 v134, v134, v131
    v_mul_f32 v135, v135, v131
    v_accvgpr_write_b32 a52, v132
    v_accvgpr_write_b32 a53, v133
    v_accvgpr_write_b32 a54, v134
    v_accvgpr_write_b32 a55, v135
    v_accvgpr_read_b32 v132, a56
    v_accvgpr_read_b32 v133, a57
    v_accvgpr_read_b32 v134, a58
    v_accvgpr_read_b32 v135, a59
    v_mul_f32 v132, v132, v131
    v_mul_f32 v133, v133, v131
    v_mul_f32 v134, v134, v131
    v_mul_f32 v135, v135, v131
    v_accvgpr_write_b32 a56, v132
    v_accvgpr_write_b32 a57, v133
    v_accvgpr_write_b32 a58, v134
    v_accvgpr_write_b32 a59, v135
    v_accvgpr_read_b32 v132, a60
    v_accvgpr_read_b32 v133, a61
    v_accvgpr_read_b32 v134, a62
    v_accvgpr_read_b32 v135, a63
    v_mul_f32 v132, v132, v131
    v_mul_f32 v133, v133, v131
    v_mul_f32 v134, v134, v131
    v_mul_f32 v135, v135, v131
    v_accvgpr_write_b32 a60, v132
    v_accvgpr_write_b32 a61, v133
    v_accvgpr_write_b32 a62, v134
    v_accvgpr_write_b32 a63, v135
    v_max3_f32 v130, v48, v49, v50
    v_max3_f32 v130, v130, v51, v52
    v_max3_f32 v130, v130, v53, v54
    v_max3_f32 v130, v130, v55, v56
    v_max3_f32 v130, v130, v57, v58
    v_max3_f32 v130, v130, v59, v60
    v_max3_f32 v130, v130, v61, v62
    v_max_f32 v130, v130, v63
    v_mov_b32 v131, v130
    s_nop 1
    v_permlane32_swap_b32 v130, v131
    s_nop 1
    v_max_f32 v130, v130, v131
    v_max_f32 v130, 0, v130
    v_sub_f32 v131, 0, v130
    v_exp_f32 v131, v131
    v_sub_f32 v48, v48, v130
    v_sub_f32 v16, v16, v130
    v_sub_f32 v160, v160, v130
    v_sub_f32 v49, v49, v130
    v_sub_f32 v17, v17, v130
    v_sub_f32 v161, v161, v130
    v_sub_f32 v50, v50, v130
    v_sub_f32 v18, v18, v130
    v_sub_f32 v162, v162, v130
    v_sub_f32 v51, v51, v130
    v_sub_f32 v19, v19, v130
    v_sub_f32 v163, v163, v130
    v_sub_f32 v52, v52, v130
    v_sub_f32 v20, v20, v130
    v_sub_f32 v164, v164, v130
    v_sub_f32 v53, v53, v130
    v_sub_f32 v21, v21, v130
    v_sub_f32 v165, v165, v130
    v_sub_f32 v54, v54, v130
    v_sub_f32 v22, v22, v130
    v_sub_f32 v166, v166, v130
    v_sub_f32 v55, v55, v130
    v_sub_f32 v23, v23, v130
    v_sub_f32 v167, v167, v130
    v_sub_f32 v56, v56, v130
    v_sub_f32 v24, v24, v130
    v_sub_f32 v168, v168, v130
    v_sub_f32 v57, v57, v130
    v_sub_f32 v25, v25, v130
    v_sub_f32 v169, v169, v130
    v_sub_f32 v58, v58, v130
    v_sub_f32 v26, v26, v130
    v_sub_f32 v170, v170, v130
    v_sub_f32 v59, v59, v130
    v_sub_f32 v27, v27, v130
    v_sub_f32 v171, v171, v130
    v_sub_f32 v60, v60, v130
    v_sub_f32 v28, v28, v130
    v_sub_f32 v172, v172, v130
    v_sub_f32 v61, v61, v130
    v_sub_f32 v29, v29, v130
    v_sub_f32 v173, v173, v130
    v_sub_f32 v62, v62, v130
    v_sub_f32 v30, v30, v130
    v_sub_f32 v174, v174, v130
    v_sub_f32 v63, v63, v130
    v_sub_f32 v31, v31, v130
    v_sub_f32 v175, v175, v130
    v_mul_f32 v109, v109, v131
    v_accvgpr_read_b32 v132, a64
    v_accvgpr_read_b32 v133, a65
    v_accvgpr_read_b32 v134, a66
    v_accvgpr_read_b32 v135, a67
    v_mul_f32 v132, v132, v131
    v_mul_f32 v133, v133, v131
    v_mul_f32 v134, v134, v131
    v_mul_f32 v135, v135, v131
    v_accvgpr_write_b32 a64, v132
    v_accvgpr_write_b32 a65, v133
    v_accvgpr_write_b32 a66, v134
    v_accvgpr_write_b32 a67, v135
    v_accvgpr_read_b32 v132, a68
    v_accvgpr_read_b32 v133, a69
    v_accvgpr_read_b32 v134, a70
    v_accvgpr_read_b32 v135, a71
    v_mul_f32 v132, v132, v131
    v_mul_f32 v133, v133, v131
    v_mul_f32 v134, v134, v131
    v_mul_f32 v135, v135, v131
    v_accvgpr_write_b32 a68, v132
    v_accvgpr_write_b32 a69, v133
    v_accvgpr_write_b32 a70, v134
    v_accvgpr_write_b32 a71, v135
    v_accvgpr_read_b32 v132, a72
    v_accvgpr_read_b32 v133, a73
    v_accvgpr_read_b32 v134, a74
    v_accvgpr_read_b32 v135, a75
    v_mul_f32 v132, v132, v131
    v_mul_f32 v133, v133, v131
    v_mul_f32 v134, v134, v131
    v_mul_f32 v135, v135, v131
    v_accvgpr_write_b32 a72, v132
    v_accvgpr_write_b32 a73, v133
    v_accvgpr_write_b32 a74, v134
    v_accvgpr_write_b32 a75, v135
    v_accvgpr_read_b32 v132, a76
    v_accvgpr_read_b32 v133, a77
    v_accvgpr_read_b32 v134, a78
    v_accvgpr_read_b32 v135, a79
    v_mul_f32 v132, v132, v131
    v_mul_f32 v133, v133, v131
    v_mul_f32 v134, v134, v131
    v_mul_f32 v135, v135, v131
    v_accvgpr_write_b32 a76, v132
    v_accvgpr_write_b32 a77, v133
    v_accvgpr_write_b32 a78, v134
    v_accvgpr_write_b32 a79, v135
    v_accvgpr_read_b32 v132, a80
    v_accvgpr_read_b32 v133, a81
    v_accvgpr_read_b32 v134, a82
    v_accvgpr_read_b32 v135, a83
    v_mul_f32 v132, v132, v131
    v_mul_f32 v133, v133, v131
    v_mul_f32 v134, v134, v131
    v_mul_f32 v135, v135, v131
    v_accvgpr_write_b32 a80, v132
    v_accvgpr_write_b32 a81, v133
    v_accvgpr_write_b32 a82, v134
    v_accvgpr_write_b32 a83, v135
    v_accvgpr_read_b32 v132, a84
    v_accvgpr_read_b32 v133, a85
    v_accvgpr_read_b32 v134, a86
    v_accvgpr_read_b32 v135, a87
    v_mul_f32 v132, v132, v131
    v_mul_f32 v133, v133, v131
    v_mul_f32 v134, v134, v131
    v_mul_f32 v135, v135, v131
    v_accvgpr_write_b32 a84, v132
    v_accvgpr_write_b32 a85, v133
    v_accvgpr_write_b32 a86, v134
    v_accvgpr_write_b32 a87, v135
    v_accvgpr_read_b32 v132, a88
    v_accvgpr_read_b32 v133, a89
    v_accvgpr_read_b32 v134, a90
    v_accvgpr_read_b32 v135, a91
    v_mul_f32 v132, v132, v131
    v_mul_f32 v133, v133, v131
    v_mul_f32 v134, v134, v131
    v_mul_f32 v135, v135, v131
    v_accvgpr_write_b32 a88, v132
    v_accvgpr_write_b32 a89, v133
    v_accvgpr_write_b32 a90, v134
    v_accvgpr_write_b32 a91, v135
    v_accvgpr_read_b32 v132, a92
    v_accvgpr_read_b32 v133, a93
    v_accvgpr_read_b32 v134, a94
    v_accvgpr_read_b32 v135, a95
    v_mul_f32 v132, v132, v131
    v_mul_f32 v133, v133, v131
    v_mul_f32 v134, v134, v131
    v_mul_f32 v135, v135, v131
    v_accvgpr_write_b32 a92, v132
    v_accvgpr_write_b32 a93, v133
    v_accvgpr_write_b32 a94, v134
    v_accvgpr_write_b32 a95, v135
    v_accvgpr_read_b32 v132, a96
    v_accvgpr_read_b32 v133, a97
    v_accvgpr_read_b32 v134, a98
    v_accvgpr_read_b32 v135, a99
    v_mul_f32 v132, v132, v131
    v_mul_f32 v133, v133, v131
    v_mul_f32 v134, v134, v131
    v_mul_f32 v135, v135, v131
    v_accvgpr_write_b32 a96, v132
    v_accvgpr_write_b32 a97, v133
    v_accvgpr_write_b32 a98, v134
    v_accvgpr_write_b32 a99, v135
    v_accvgpr_read_b32 v132, a100
    v_accvgpr_read_b32 v133, a101
    v_accvgpr_read_b32 v134, a102
    v_accvgpr_read_b32 v135, a103
    v_mul_f32 v132, v132, v131
    v_mul_f32 v133, v133, v131
    v_mul_f32 v134, v134, v131
    v_mul_f32 v135, v135, v131
    v_accvgpr_write_b32 a100, v132
    v_accvgpr_write_b32 a101, v133
    v_accvgpr_write_b32 a102, v134
    v_accvgpr_write_b32 a103, v135
    v_accvgpr_read_b32 v132, a104
    v_accvgpr_read_b32 v133, a105
    v_accvgpr_read_b32 v134, a106
    v_accvgpr_read_b32 v135, a107
    v_mul_f32 v132, v132, v131
    v_mul_f32 v133, v133, v131
    v_mul_f32 v134, v134, v131
    v_mul_f32 v135, v135, v131
    v_accvgpr_write_b32 a104, v132
    v_accvgpr_write_b32 a105, v133
    v_accvgpr_write_b32 a106, v134
    v_accvgpr_write_b32 a107, v135
    v_accvgpr_read_b32 v132, a108
    v_accvgpr_read_b32 v133, a109
    v_accvgpr_read_b32 v134, a110
    v_accvgpr_read_b32 v135, a111
    v_mul_f32 v132, v132, v131
    v_mul_f32 v133, v133, v131
    v_mul_f32 v134, v134, v131
    v_mul_f32 v135, v135, v131
    v_accvgpr_write_b32 a108, v132
    v_accvgpr_write_b32 a109, v133
    v_accvgpr_write_b32 a110, v134
    v_accvgpr_write_b32 a111, v135
    v_accvgpr_read_b32 v132, a112
    v_accvgpr_read_b32 v133, a113
    v_accvgpr_read_b32 v134, a114
    v_accvgpr_read_b32 v135, a115
    v_mul_f32 v132, v132, v131
    v_mul_f32 v133, v133, v131
    v_mul_f32 v134, v134, v131
    v_mul_f32 v135, v135, v131
    v_accvgpr_write_b32 a112, v132
    v_accvgpr_write_b32 a113, v133
    v_accvgpr_write_b32 a114, v134
    v_accvgpr_write_b32 a115, v135
    v_accvgpr_read_b32 v132, a116
    v_accvgpr_read_b32 v133, a117
    v_accvgpr_read_b32 v134, a118
    v_accvgpr_read_b32 v135, a119
    v_mul_f32 v132, v132, v131
    v_mul_f32 v133, v133, v131
    v_mul_f32 v134, v134, v131
    v_mul_f32 v135, v135, v131
    v_accvgpr_write_b32 a116, v132
    v_accvgpr_write_b32 a117, v133
    v_accvgpr_write_b32 a118, v134
    v_accvgpr_write_b32 a119, v135
    v_accvgpr_read_b32 v132, a120
    v_accvgpr_read_b32 v133, a121
    v_accvgpr_read_b32 v134, a122
    v_accvgpr_read_b32 v135, a123
    v_mul_f32 v132, v132, v131
    v_mul_f32 v133, v133, v131
    v_mul_f32 v134, v134, v131
    v_mul_f32 v135, v135, v131
    v_accvgpr_write_b32 a120, v132
    v_accvgpr_write_b32 a121, v133
    v_accvgpr_write_b32 a122, v134
    v_accvgpr_write_b32 a123, v135
    v_accvgpr_read_b32 v132, a124
    v_accvgpr_read_b32 v133, a125
    v_accvgpr_read_b32 v134, a126
    v_accvgpr_read_b32 v135, a127
    v_mul_f32 v132, v132, v131
    v_mul_f32 v133, v133, v131
    v_mul_f32 v134, v134, v131
    v_mul_f32 v135, v135, v131
    v_accvgpr_write_b32 a124, v132
    v_accvgpr_write_b32 a125, v133
    v_accvgpr_write_b32 a126, v134
    v_accvgpr_write_b32 a127, v135
    v_exp_f32 v96, v32
    v_exp_f32 v97, v33
    v_exp_f32 v98, v34
    v_exp_f32 v99, v35
    v_exp_f32 v100, v36
    v_exp_f32 v101, v37
    v_mov_b32 v104, v96
    v_mov_b32 v105, v97
    v_cvt_pk_bf16_f32 v80, v96, v97
    v_exp_f32 v102, v38
    v_exp_f32 v103, v39
    v_add_f32 v104, v104, v98
    v_add_f32 v105, v105, v99
    v_cvt_pk_bf16_f32 v81, v98, v99
    v_exp_f32 v96, v40
    v_exp_f32 v97, v41
    v_add_f32 v104, v104, v100
    v_add_f32 v105, v105, v101
    v_cvt_pk_bf16_f32 v82, v100, v101
    v_exp_f32 v98, v42
    v_exp_f32 v99, v43
    v_add_f32 v104, v104, v102
    v_add_f32 v105, v105, v103
    v_cvt_pk_bf16_f32 v83, v102, v103
    v_exp_f32 v100, v44
    v_exp_f32 v101, v45
    v_add_f32 v104, v104, v96
    v_add_f32 v105, v105, v97
    v_cvt_pk_bf16_f32 v84, v96, v97
    v_exp_f32 v102, v46
    v_exp_f32 v103, v47
    v_add_f32 v104, v104, v98
    v_add_f32 v105, v105, v99
    v_cvt_pk_bf16_f32 v85, v98, v99
    v_exp_f32 v96, v48
    v_exp_f32 v97, v49
    v_add_f32 v104, v104, v100
    v_add_f32 v105, v105, v101
    v_cvt_pk_bf16_f32 v86, v100, v101
    v_exp_f32 v98, v50
    v_exp_f32 v99, v51
    v_add_f32 v104, v104, v102
    v_add_f32 v105, v105, v103
    v_cvt_pk_bf16_f32 v87, v102, v103
    v_exp_f32 v100, v52
    v_exp_f32 v101, v53
    v_mov_b32 v106, v96
    v_mov_b32 v107, v97
    v_cvt_pk_bf16_f32 v88, v96, v97
    v_exp_f32 v102, v54
    v_exp_f32 v103, v55
    v_add_f32 v106, v106, v98
    v_add_f32 v107, v107, v99
    v_cvt_pk_bf16_f32 v89, v98, v99
    v_exp_f32 v96, v56
    v_exp_f32 v97, v57
    v_add_f32 v106, v106, v100
    v_add_f32 v107, v107, v101
    v_cvt_pk_bf16_f32 v90, v100, v101
    v_exp_f32 v98, v58
    v_exp_f32 v99, v59
    v_add_f32 v106, v106, v102
    v_add_f32 v107, v107, v103
    v_cvt_pk_bf16_f32 v91, v102, v103
    v_exp_f32 v100, v60
    v_exp_f32 v101, v61
    v_add_f32 v106, v106, v96
    v_add_f32 v107, v107, v97
    v_cvt_pk_bf16_f32 v92, v96, v97
    v_exp_f32 v102, v62
    v_exp_f32 v103, v63
    v_add_f32 v106, v106, v98
    v_add_f32 v107, v107, v99
    v_cvt_pk_bf16_f32 v93, v98, v99
    v_add_f32 v106, v106, v100
    v_add_f32 v107, v107, v101
    v_cvt_pk_bf16_f32 v94, v100, v101
    v_add_f32 v106, v106, v102
    v_add_f32 v107, v107, v103
    v_cvt_pk_bf16_f32 v95, v102, v103
    v_add_f32 v104, v104, v105
    v_add_f32 v106, v106, v107
    s_nop 1
    s_branch at_back1
at_fin:
at_done:
    s_endpgm
.globl out_kernel
.p2align 8
.type out_kernel,@function
out_kernel:
    s_cmp_ge_u32 s2, 256
    s_cbranch_scc1 k3_done
    s_load_dwordx2 s[4:5], s[0:1], 0
    s_load_dwordx2 s[10:11], s[0:1], 72
    s_load_dwordx2 s[12:13], s[0:1], 88
    s_and_b32 s38, s2, 7
    s_lshr_b32 s39, s2, 3
    s_and_b32 s40, s39, 3
    s_lshl_b32 s16, s38, 2
    s_add_u32 s16, s16, s40
    s_lshr_b32 s17, s2, 5
    v_lshrrev_b32 v1, 6, v0
    v_and_b32 v0, 63, v0
    v_mov_b32 v216, v0
    s_nop 0
    v_readfirstlane_b32 s18, v1
    s_waitcnt lgkmcnt(0)
    s_add_u32 s40, s12, 0x2000000
    s_addc_u32 s41, s13, 0
    s_mov_b32 s20, s40
    s_and_b32 s21, s41, 0xffff
    s_mov_b32 s22, 0x1700000
    s_mov_b32 s23, 0x00020000
    s_add_u32 s40, s12, 0x3800000
    s_addc_u32 s41, s13, 0
    s_mov_b32 s24, s40
    s_and_b32 s25, s41, 0xffff
    s_mov_b32 s26, 0x5c0000
    s_mov_b32 s27, 0x00020000
    s_lshl_b32 s38, s16, 6
    s_lshl_b32 s39, s18, 4
    s_add_u32 s38, s38, s39
    s_lshl_b32 s28, s38, 8
    s_lshr_b32 s38, s17, 1
    s_mul_i32 s29, s38, 0x170000
    s_and_b32 s38, s17, 1
    s_lshl_b32 s38, s38, 7
    s_add_u32 s29, s29, s38
    s_lshl_b32 s38, s18, 13
    s_add_u32 s29, s29, s38
    s_lshl_b32 s31, s18, 12
    s_add_u32 s32, s31, 0x4000
    s_mov_b32 s48, 0x8000
    s_mov_b32 s49, 0xfffe0000
    v_lshrrev_b32 v1, 4, v0
    v_and_b32 v2, 15, v0
    v_add_u32 v3, 0, v1
    v_xor_b32 v4, v2, v3
    v_lshlrev_b32 v4, 4, v4
    v_lshl_add_u32 v200, v1, 8, v4
    v_add_u32 v3, 4, v1
    v_xor_b32 v4, v2, v3
    v_lshlrev_b32 v4, 4, v4
    v_lshl_add_u32 v201, v1, 8, v4
    v_add_u32 v3, 8, v1
    v_xor_b32 v4, v2, v3
    v_lshlrev_b32 v4, 4, v4
    v_lshl_add_u32 v202, v1, 8, v4
    v_add_u32 v3, 12, v1
    v_xor_b32 v4, v2, v3
    v_lshlrev_b32 v4, 4, v4
    v_lshl_add_u32 v203, v1, 8, v4
    v_lshrrev_b32 v1, 3, v0
    v_and_b32 v2, 7, v0
    v_lshrrev_b32 v3, 4, v0
    v_and_b32 v3, 1, v3
    v_lshlrev_b32 v3, 2, v3
    v_xor_b32 v2, v2, v3
    v_lshlrev_b32 v2, 4, v2
    v_lshl_add_u32 v2, v1, 8, v2
    v_add_u32 v204, 0, v2
    v_add_u32 v205, 1024, v2
    v_add_u32 v206, 2048, v2
    v_add_u32 v207, 3072, v2
    s_mov_b32 s33, 0
    s_add_u32 m0, s31, s33
    s_nop 0
    buffer_load_dwordx4 v200, s[20:23], s28 offen offset:0 lds
    buffer_load_dwordx4 v201, s[20:23], s28 offen offset:1024 lds
    buffer_load_dwordx4 v202, s[20:23], s28 offen offset:2048 lds
    buffer_load_dwordx4 v203, s[20:23], s28 offen offset:3072 lds
    s_add_u32 m0, s32, s33
    s_nop 0
    buffer_load_dwordx4 v204, s[24:27], s29 offen offset:0 lds
    buffer_load_dwordx4 v205, s[24:27], s29 offen offset:1024 lds
    buffer_load_dwordx4 v206, s[24:27], s29 offen offset:2048 lds
    buffer_load_dwordx4 v207, s[24:27], s29 offen offset:3072 lds
    s_add_u32 s28, s28, 0x80000
    s_add_u32 s29, s29, 0x8000
    s_add_u32 s33, s33, 0x8000
    s_cmp_eq_u32 s33, 0x28000
    s_cselect_b32 s33, 0, s33
    s_add_u32 m0, s31, s33
    s_nop 0
    buffer_load_dwordx4 v200, s[20:23], s28 offen offset:0 lds
    buffer_load_dwordx4 v201, s[20:23], s28 offen offset:1024 lds
    buffer_load_dwordx4 v202, s[20:23], s28 offen offset:2048 lds
    buffer_load_dwordx4 v203, s[20:23], s28 offen offset:3072 lds
    s_add_u32 m0, s32, s33
    s_nop 0
    buffer_load_dwordx4 v204, s[24:27], s29 offen offset:0 lds
    buffer_load_dwordx4 v205, s[24:27], s29 offen offset:1024 lds
    buffer_load_dwordx4 v206, s[24:27], s29 offen offset:2048 lds
    buffer_load_dwordx4 v207, s[24:27], s29 offen offset:3072 lds
    s_add_u32 s28, s28, 0x80000
    s_add_u32 s29, s29, 0x8000
    s_add_u32 s33, s33, 0x8000
    s_cmp_eq_u32 s33, 0x28000
    s_cselect_b32 s33, 0, s33
    s_add_u32 m0, s31, s33
    s_nop 0
    buffer_load_dwordx4 v200, s[20:23], s28 offen offset:0 lds
    buffer_load_dwordx4 v201, s[20:23], s28 offen offset:1024 lds
    buffer_load_dwordx4 v202, s[20:23], s28 offen offset:2048 lds
    buffer_load_dwordx4 v203, s[20:23], s28 offen offset:3072 lds
    s_add_u32 m0, s32, s33
    s_nop 0
    buffer_load_dwordx4 v204, s[24:27], s29 offen offset:0 lds
    buffer_load_dwordx4 v205, s[24:27], s29 offen offset:1024 lds
    buffer_load_dwordx4 v206, s[24:27], s29 offen offset:2048 lds
    buffer_load_dwordx4 v207, s[24:27], s29 offen offset:3072 lds
    s_add_u32 s28, s28, 0x80000
    s_add_u32 s29, s29, 0x8000
    s_add_u32 s33, s33, 0x8000
    s_cmp_eq_u32 s33, 0x28000
    s_cselect_b32 s33, 0, s33
    s_add_u32 m0, s31, s33
    s_nop 0
    buffer_load_dwordx4 v200, s[20:23], s28 offen offset:0 lds
    buffer_load_dwordx4 v201, s[20:23], s28 offen offset:1024 lds
    buffer_load_dwordx4 v202, s[20:23], s28 offen offset:2048 lds
    buffer_load_dwordx4 v203, s[20:23], s28 offen offset:3072 lds
    s_add_u32 m0, s32, s33
    s_nop 0
    buffer_load_dwordx4 v204, s[24:27], s29 offen offset:0 lds
    buffer_load_dwordx4 v205, s[24:27], s29 offen offset:1024 lds
    buffer_load_dwordx4 v206, s[24:27], s29 offen offset:2048 lds
    buffer_load_dwordx4 v207, s[24:27], s29 offen offset:3072 lds
    s_add_u32 s28, s28, 0x80000
    s_add_u32 s29, s29, 0x8000
    s_add_u32 s33, s33, 0x8000
    s_cmp_eq_u32 s33, 0x28000
    s_cselect_b32 s33, 0, s33
    v_and_b32 v1, 31, v0
    v_lshrrev_b32 v2, 5, v0
    v_and_b32 v3, 15, v0
    v_lshlrev_b32 v4, 8, v1
    s_lshl_b32 s38, s18, 1
    v_add_u32 v5, s38, v2
    v_xor_b32 v6, v5, v3
    v_lshl_add_u32 v212, v6, 4, v4
    v_xor_b32 v6, 8, v6
    v_lshl_add_u32 v213, v6, 4, v4
    v_lshrrev_b32 v1, 4, v0
    v_and_b32 v1, 1, v1
    v_lshrrev_b32 v3, 2, v3
    v_and_b32 v4, 3, v0
    v_lshrrev_b32 v5, 1, v4
    v_lshl_add_u32 v5, v1, 1, v5
    v_lshrrev_b32 v6, 1, v3
    v_lshlrev_b32 v6, 2, v6
    v_xor_b32 v5, v5, v6
    v_xor_b32 v6, 4, v5
    v_lshl_add_u32 v7, v2, 3, v3
    s_lshl_b32 s38, s18, 4
    v_add_u32 v7, s38, v7
    v_lshlrev_b32 v7, 7, v7
    v_and_b32 v4, 1, v4
    v_lshl_add_u32 v7, v4, 3, v7
    v_add_u32 v7, 0x4000, v7
    v_lshl_add_u32 v214, v5, 4, v7
    v_lshl_add_u32 v215, v6, 4, v7
    v_accvgpr_write_b32 a0, 0
    v_accvgpr_write_b32 a1, 0
    v_accvgpr_write_b32 a2, 0
    v_accvgpr_write_b32 a3, 0
    v_accvgpr_write_b32 a4, 0
    v_accvgpr_write_b32 a5, 0
    v_accvgpr_write_b32 a6, 0
    v_accvgpr_write_b32 a7, 0
    v_accvgpr_write_b32 a8, 0
    v_accvgpr_write_b32 a9, 0
    v_accvgpr_write_b32 a10, 0
    v_accvgpr_write_b32 a11, 0
    v_accvgpr_write_b32 a12, 0
    v_accvgpr_write_b32 a13, 0
    v_accvgpr_write_b32 a14, 0
    v_accvgpr_write_b32 a15, 0
    v_accvgpr_write_b32 a16, 0
    v_accvgpr_write_b32 a17, 0
    v_accvgpr_write_b32 a18, 0
    v_accvgpr_write_b32 a19, 0
    v_accvgpr_write_b32 a20, 0
    v_accvgpr_write_b32 a21, 0
    v_accvgpr_write_b32 a22, 0
    v_accvgpr_write_b32 a23, 0
    v_accvgpr_write_b32 a24, 0
    v_accvgpr_write_b32 a25, 0
    v_accvgpr_write_b32 a26, 0
    v_accvgpr_write_b32 a27, 0
    v_accvgpr_write_b32 a28, 0
    v_accvgpr_write_b32 a29, 0
    v_accvgpr_write_b32 a30, 0
    v_accvgpr_write_b32 a31, 0
    v_accvgpr_write_b32 a32, 0
    v_accvgpr_write_b32 a33, 0
    v_accvgpr_write_b32 a34, 0
    v_accvgpr_write_b32 a35, 0
    v_accvgpr_write_b32 a36, 0
    v_accvgpr_write_b32 a37, 0
    v_accvgpr_write_b32 a38, 0
    v_accvgpr_write_b32 a39, 0
    v_accvgpr_write_b32 a40, 0
    v_accvgpr_write_b32 a41, 0
    v_accvgpr_write_b32 a42, 0
    v_accvgpr_write_b32 a43, 0
    v_accvgpr_write_b32 a44, 0
    v_accvgpr_write_b32 a45, 0
    v_accvgpr_write_b32 a46, 0
    v_accvgpr_write_b32 a47, 0
    v_accvgpr_write_b32 a48, 0
    v_accvgpr_write_b32 a49, 0
    v_accvgpr_write_b32 a50, 0
    v_accvgpr_write_b32 a51, 0
    v_accvgpr_write_b32 a52, 0
    v_accvgpr_write_b32 a53, 0
    v_accvgpr_write_b32 a54, 0
    v_accvgpr_write_b32 a55, 0
    v_accvgpr_write_b32 a56, 0
    v_accvgpr_write_b32 a57, 0
    v_accvgpr_write_b32 a58, 0
    v_accvgpr_write_b32 a59, 0
    v_accvgpr_write_b32 a60, 0
    v_accvgpr_write_b32 a61, 0
    v_accvgpr_write_b32 a62, 0
    v_accvgpr_write_b32 a63, 0
    v_accvgpr_write_b32 a64, 0
    v_accvgpr_write_b32 a65, 0
    v_accvgpr_write_b32 a66, 0
    v_accvgpr_write_b32 a67, 0
    v_accvgpr_write_b32 a68, 0
    v_accvgpr_write_b32 a69, 0
    v_accvgpr_write_b32 a70, 0
    v_accvgpr_write_b32 a71, 0
    v_accvgpr_write_b32 a72, 0
    v_accvgpr_write_b32 a73, 0
    v_accvgpr_write_b32 a74, 0
    v_accvgpr_write_b32 a75, 0
    v_accvgpr_write_b32 a76, 0
    v_accvgpr_write_b32 a77, 0
    v_accvgpr_write_b32 a78, 0
    v_accvgpr_write_b32 a79, 0
    v_accvgpr_write_b32 a80, 0
    v_accvgpr_write_b32 a81, 0
    v_accvgpr_write_b32 a82, 0
    v_accvgpr_write_b32 a83, 0
    v_accvgpr_write_b32 a84, 0
    v_accvgpr_write_b32 a85, 0
    v_accvgpr_write_b32 a86, 0
    v_accvgpr_write_b32 a87, 0
    v_accvgpr_write_b32 a88, 0
    v_accvgpr_write_b32 a89, 0
    v_accvgpr_write_b32 a90, 0
    v_accvgpr_write_b32 a91, 0
    v_accvgpr_write_b32 a92, 0
    v_accvgpr_write_b32 a93, 0
    v_accvgpr_write_b32 a94, 0
    v_accvgpr_write_b32 a95, 0
    v_accvgpr_write_b32 a96, 0
    v_accvgpr_write_b32 a97, 0
    v_accvgpr_write_b32 a98, 0
    v_accvgpr_write_b32 a99, 0
    v_accvgpr_write_b32 a100, 0
    v_accvgpr_write_b32 a101, 0
    v_accvgpr_write_b32 a102, 0
    v_accvgpr_write_b32 a103, 0
    v_accvgpr_write_b32 a104, 0
    v_accvgpr_write_b32 a105, 0
    v_accvgpr_write_b32 a106, 0
    v_accvgpr_write_b32 a107, 0
    v_accvgpr_write_b32 a108, 0
    v_accvgpr_write_b32 a109, 0
    v_accvgpr_write_b32 a110, 0
    v_accvgpr_write_b32 a111, 0
    v_accvgpr_write_b32 a112, 0
    v_accvgpr_write_b32 a113, 0
    v_accvgpr_write_b32 a114, 0
    v_accvgpr_write_b32 a115, 0
    v_accvgpr_write_b32 a116, 0
    v_accvgpr_write_b32 a117, 0
    v_accvgpr_write_b32 a118, 0
    v_accvgpr_write_b32 a119, 0
    v_accvgpr_write_b32 a120, 0
    v_accvgpr_write_b32 a121, 0
    v_accvgpr_write_b32 a122, 0
    v_accvgpr_write_b32 a123, 0
    v_accvgpr_write_b32 a124, 0
    v_accvgpr_write_b32 a125, 0
    v_accvgpr_write_b32 a126, 0
    v_accvgpr_write_b32 a127, 0
    s_mov_b32 s46, 0
    s_waitcnt vmcnt(24) lgkmcnt(0)
    s_barrier
    ds_read_b128 v[8:11], v212 offset:0
    ds_read_b64_tr_b16 v[0:1], v214 offset:0
    ds_read_b64_tr_b16 v[2:3], v214 offset:512
    ds_read_b128 v[12:15], v212 offset:8192
    ds_read_b64_tr_b16 v[4:5], v215 offset:0
    ds_read_b64_tr_b16 v[6:7], v215 offset:512
    s_add_u32 m0, s31, s33
    s_nop 0
    buffer_load_dwordx4 v200, s[20:23], s28 offen offset:0 lds
    ds_read_b128 v[24:27], v213 offset:0
    buffer_load_dwordx4 v201, s[20:23], s28 offen offset:1024 lds
    ds_read_b64_tr_b16 v[16:17], v214 offset:8192
    buffer_load_dwordx4 v202, s[20:23], s28 offen offset:2048 lds
    ds_read_b64_tr_b16 v[18:19], v214 offset:8704
    buffer_load_dwordx4 v203, s[20:23], s28 offen offset:3072 lds
    ds_read_b128 v[28:31], v213 offset:8192
    s_add_u32 m0, s32, s33
    s_nop 0
    buffer_load_dwordx4 v204, s[24:27], s29 offen offset:0 lds
    ds_read_b64_tr_b16 v[20:21], v215 offset:8192
    buffer_load_dwordx4 v205, s[24:27], s29 offen offset:1024 lds
    ds_read_b64_tr_b16 v[22:23], v215 offset:8704
    buffer_load_dwordx4 v206, s[24:27], s29 offen offset:2048 lds
    buffer_load_dwordx4 v207, s[24:27], s29 offen offset:3072 lds
    s_add_u32 s28, s28, 0x80000
    s_add_u32 s29, s29, 0x8000
    s_add_u32 s33, s33, 0x8000
    s_cmp_eq_u32 s33, 0x28000
    s_cselect_b32 s33, 0, s33
    s_add_u32 s46, s46, 1
    s_cmp_eq_u32 s46, 5
    s_cselect_b32 s50, s49, s48
    s_cselect_b32 s46, 0, s46
    v_add_u32 v212, s50, v212
    v_add_u32 v213, s50, v213
    v_add_u32 v214, s50, v214
    v_add_u32 v215, s50, v215
    s_mov_b32 s35, 0
k3_loop0:
    s_waitcnt vmcnt(24) lgkmcnt(0)
    s_barrier
    ds_read_b128 v[40:43], v212 offset:0
    ds_read_b64_tr_b16 v[32:33], v214 offset:0
    ds_read_b64_tr_b16 v[34:35], v214 offset:512
    ds_read_b128 v[44:47], v212 offset:8192
    ds_read_b64_tr_b16 v[36:37], v215 offset:0
    ds_read_b64_tr_b16 v[38:39], v215 offset:512
    s_add_u32 m0, s31, s33
    s_nop 0
    buffer_load_dwordx4 v200, s[20:23], s28 offen offset:0 lds
    v_mfma_f32_32x32x16_bf16 a[0:15], v[0:3], v[8:11], a[0:15]
    ds_read_b128 v[56:59], v213 offset:0
    buffer_load_dwordx4 v201, s[20:23], s28 offen offset:1024 lds
    v_mfma_f32_32x32x16_bf16 a[16:31], v[0:3], v[12:15], a[16:31]
    ds_read_b64_tr_b16 v[48:49], v214 offset:8192
    buffer_load_dwordx4 v202, s[20:23], s28 offen offset:2048 lds
    v_mfma_f32_32x32x16_bf16 a[32:47], v[4:7], v[8:11], a[32:47]
    ds_read_b64_tr_b16 v[50:51], v214 offset:8704
    buffer_load_dwordx4 v203, s[20:23], s28 offen offset:3072 lds
    v_mfma_f32_32x32x16_bf16 a[48:63], v[4:7], v[12:15], a[48:63]
    ds_read_b128 v[60:63], v213 offset:8192
    s_add_u32 m0, s32, s33
    s_nop 0
    buffer_load_dwordx4 v204, s[24:27], s29 offen offset:0 lds
    v_mfma_f32_32x32x16_bf16 a[0:15], v[16:19], v[24:27], a[0:15]
    ds_read_b64_tr_b16 v[52:53], v215 offset:8192
    buffer_load_dwordx4 v205, s[24:27], s29 offen offset:1024 lds
    v_mfma_f32_32x32x16_bf16 a[16:31], v[16:19], v[28:31], a[16:31]
    ds_read_b64_tr_b16 v[54:55], v215 offset:8704
    buffer_load_dwordx4 v206, s[24:27], s29 offen offset:2048 lds
    v_mfma_f32_32x32x16_bf16 a[32:47], v[20:23], v[24:27], a[32:47]
    buffer_load_dwordx4 v207, s[24:27], s29 offen offset:3072 lds
    v_mfma_f32_32x32x16_bf16 a[48:63], v[20:23], v[28:31], a[48:63]
    s_add_u32 s28, s28, 0x80000
    s_add_u32 s29, s29, 0x8000
    s_add_u32 s33, s33, 0x8000
    s_cmp_eq_u32 s33, 0x28000
    s_cselect_b32 s33, 0, s33
    s_add_u32 s46, s46, 1
    s_cmp_eq_u32 s46, 5
    s_cselect_b32 s50, s49, s48
    s_cselect_b32 s46, 0, s46
    v_add_u32 v212, s50, v212
    v_add_u32 v213, s50, v213
    v_add_u32 v214, s50, v214
    v_add_u32 v215, s50, v215
    s_waitcnt vmcnt(24) lgkmcnt(0)
    s_barrier
    ds_read_b128 v[8:11], v212 offset:0
    ds_read_b64_tr_b16 v[0:1], v214 offset:0
    ds_read_b64_tr_b16 v[2:3], v214 offset:512
    ds_read_b128 v[12:15], v212 offset:8192
    ds_read_b64_tr_b16 v[4:5], v215 offset:0
    ds_read_b64_tr_b16 v[6:7], v215 offset:512
    s_add_u32 m0, s31, s33
    s_nop 0
    buffer_load_dwordx4 v200, s[20:23], s28 offen offset:0 lds
    v_mfma_f32_32x32x16_bf16 a[0:15], v[32:35], v[40:43], a[0:15]
    ds_read_b128 v[24:27], v213 offset:0
    buffer_load_dwordx4 v201, s[20:23], s28 offen offset:1024 lds
    v_mfma_f32_32x32x16_bf16 a[16:31], v[32:35], v[44:47], a[16:31]
    ds_read_b64_tr_b16 v[16:17], v214 offset:8192
    buffer_load_dwordx4 v202, s[20:23], s28 offen offset:2048 lds
    v_mfma_f32_32x32x16_bf16 a[32:47], v[36:39], v[40:43], a[32:47]
    ds_read_b64_tr_b16 v[18:19], v214 offset:8704
    buffer_load_dwordx4 v203, s[20:23], s28 offen offset:3072 lds
    v_mfma_f32_32x32x16_bf16 a[48:63], v[36:39], v[44:47], a[48:63]
    ds_read_b128 v[28:31], v213 offset:8192
    s_add_u32 m0, s32, s33
    s_nop 0
    buffer_load_dwordx4 v204, s[24:27], s29 offen offset:0 lds
    v_mfma_f32_32x32x16_bf16 a[0:15], v[48:51], v[56:59], a[0:15]
    ds_read_b64_tr_b16 v[20:21], v215 offset:8192
    buffer_load_dwordx4 v205, s[24:27], s29 offen offset:1024 lds
    v_mfma_f32_32x32x16_bf16 a[16:31], v[48:51], v[60:63], a[16:31]
    ds_read_b64_tr_b16 v[22:23], v215 offset:8704
    buffer_load_dwordx4 v206, s[24:27], s29 offen offset:2048 lds
    v_mfma_f32_32x32x16_bf16 a[32:47], v[52:55], v[56:59], a[32:47]
    buffer_load_dwordx4 v207, s[24:27], s29 offen offset:3072 lds
    v_mfma_f32_32x32x16_bf16 a[48:63], v[52:55], v[60:63], a[48:63]
    s_add_u32 s28, s28, 0x80000
    s_add_u32 s29, s29, 0x8000
    s_add_u32 s33, s33, 0x8000
    s_cmp_eq_u32 s33, 0x28000
    s_cselect_b32 s33, 0, s33
    s_add_u32 s46, s46, 1
    s_cmp_eq_u32 s46, 5
    s_cselect_b32 s50, s49, s48
    s_cselect_b32 s46, 0, s46
    v_add_u32 v212, s50, v212
    v_add_u32 v213, s50, v213
    v_add_u32 v214, s50, v214
    v_add_u32 v215, s50, v215
    s_add_u32 s35, s35, 1
    s_cmp_lt_u32 s35, 16
    s_cbranch_scc1 k3_loop0
    s_mov_b32 s35, 0
k3_loop1:
    s_waitcnt vmcnt(24) lgkmcnt(0)
    s_barrier
    ds_read_b128 v[40:43], v212 offset:0
    ds_read_b64_tr_b16 v[32:33], v214 offset:0
    ds_read_b64_tr_b16 v[34:35], v214 offset:512
    ds_read_b128 v[44:47], v212 offset:8192
    ds_read_b64_tr_b16 v[36:37], v215 offset:0
    ds_read_b64_tr_b16 v[38:39], v215 offset:512
    s_add_u32 m0, s31, s33
    s_nop 0
    buffer_load_dwordx4 v200, s[20:23], s28 offen offset:0 lds
    v_mfma_f32_32x32x16_bf16 a[64:79], v[0:3], v[8:11], a[64:79]
    ds_read_b128 v[56:59], v213 offset:0
    buffer_load_dwordx4 v201, s[20:23], s28 offen offset:1024 lds
    v_mfma_f32_32x32x16_bf16 a[80:95], v[0:3], v[12:15], a[80:95]
    ds_read_b64_tr_b16 v[48:49], v214 offset:8192
    buffer_load_dwordx4 v202, s[20:23], s28 offen offset:2048 lds
    v_mfma_f32_32x32x16_bf16 a[96:111], v[4:7], v[8:11], a[96:111]
    ds_read_b64_tr_b16 v[50:51], v214 offset:8704
    buffer_load_dwordx4 v203, s[20:23], s28 offen offset:3072 lds
    v_mfma_f32_32x32x16_bf16 a[112:127], v[4:7], v[12:15], a[112:127]
    ds_read_b128 v[60:63], v213 offset:8192
    s_add_u32 m0, s32, s33
    s_nop 0
    buffer_load_dwordx4 v204, s[24:27], s29 offen offset:0 lds
    v_mfma_f32_32x32x16_bf16 a[64:79], v[16:19], v[24:27], a[64:79]
    ds_read_b64_tr_b16 v[52:53], v215 offset:8192
    buffer_load_dwordx4 v205, s[24:27], s29 offen offset:1024 lds
    v_mfma_f32_32x32x16_bf16 a[80:95], v[16:19], v[28:31], a[80:95]
    ds_read_b64_tr_b16 v[54:55], v215 offset:8704
    buffer_load_dwordx4 v206, s[24:27], s29 offen offset:2048 lds
    v_mfma_f32_32x32x16_bf16 a[96:111], v[20:23], v[24:27], a[96:111]
    buffer_load_dwordx4 v207, s[24:27], s29 offen offset:3072 lds
    v_mfma_f32_32x32x16_bf16 a[112:127], v[20:23], v[28:31], a[112:127]
    s_add_u32 s28, s28, 0x80000
    s_add_u32 s29, s29, 0x8000
    s_add_u32 s33, s33, 0x8000
    s_cmp_eq_u32 s33, 0x28000
    s_cselect_b32 s33, 0, s33
    s_add_u32 s46, s46, 1
    s_cmp_eq_u32 s46, 5
    s_cselect_b32 s50, s49, s48
    s_cselect_b32 s46, 0, s46
    v_add_u32 v212, s50, v212
    v_add_u32 v213, s50, v213
    v_add_u32 v214, s50, v214
    v_add_u32 v215, s50, v215
    s_waitcnt vmcnt(24) lgkmcnt(0)
    s_barrier
    ds_read_b128 v[8:11], v212 offset:0
    ds_read_b64_tr_b16 v[0:1], v214 offset:0
    ds_read_b64_tr_b16 v[2:3], v214 offset:512
    ds_read_b128 v[12:15], v212 offset:8192
    ds_read_b64_tr_b16 v[4:5], v215 offset:0
    ds_read_b64_tr_b16 v[6:7], v215 offset:512
    s_add_u32 m0, s31, s33
    s_nop 0
    buffer_load_dwordx4 v200, s[20:23], s28 offen offset:0 lds
    v_mfma_f32_32x32x16_bf16 a[64:79], v[32:35], v[40:43], a[64:79]
    ds_read_b128 v[24:27], v213 offset:0
    buffer_load_dwordx4 v201, s[20:23], s28 offen offset:1024 lds
    v_mfma_f32_32x32x16_bf16 a[80:95], v[32:35], v[44:47], a[80:95]
    ds_read_b64_tr_b16 v[16:17], v214 offset:8192
    buffer_load_dwordx4 v202, s[20:23], s28 offen offset:2048 lds
    v_mfma_f32_32x32x16_bf16 a[96:111], v[36:39], v[40:43], a[96:111]
    ds_read_b64_tr_b16 v[18:19], v214 offset:8704
    buffer_load_dwordx4 v203, s[20:23], s28 offen offset:3072 lds
    v_mfma_f32_32x32x16_bf16 a[112:127], v[36:39], v[44:47], a[112:127]
    ds_read_b128 v[28:31], v213 offset:8192
    s_add_u32 m0, s32, s33
    s_nop 0
    buffer_load_dwordx4 v204, s[24:27], s29 offen offset:0 lds
    v_mfma_f32_32x32x16_bf16 a[64:79], v[48:51], v[56:59], a[64:79]
    ds_read_b64_tr_b16 v[20:21], v215 offset:8192
    buffer_load_dwordx4 v205, s[24:27], s29 offen offset:1024 lds
    v_mfma_f32_32x32x16_bf16 a[80:95], v[48:51], v[60:63], a[80:95]
    ds_read_b64_tr_b16 v[22:23], v215 offset:8704
    buffer_load_dwordx4 v206, s[24:27], s29 offen offset:2048 lds
    v_mfma_f32_32x32x16_bf16 a[96:111], v[52:55], v[56:59], a[96:111]
    buffer_load_dwordx4 v207, s[24:27], s29 offen offset:3072 lds
    v_mfma_f32_32x32x16_bf16 a[112:127], v[52:55], v[60:63], a[112:127]
    s_add_u32 s28, s28, 0x80000
    s_add_u32 s29, s29, 0x8000
    s_add_u32 s33, s33, 0x8000
    s_cmp_eq_u32 s33, 0x28000
    s_cselect_b32 s33, 0, s33
    s_add_u32 s46, s46, 1
    s_cmp_eq_u32 s46, 5
    s_cselect_b32 s50, s49, s48
    s_cselect_b32 s46, 0, s46
    v_add_u32 v212, s50, v212
    v_add_u32 v213, s50, v213
    v_add_u32 v214, s50, v214
    v_add_u32 v215, s50, v215
    s_add_u32 s35, s35, 1
    s_cmp_lt_u32 s35, 7
    s_cbranch_scc1 k3_loop1
    s_waitcnt vmcnt(0) lgkmcnt(0)
    s_barrier
    s_nop 15
    v_mov_b32 v0, v216
    v_lshlrev_b32 v1, 4, v0
    s_lshl_b32 s38, s18, 15
    v_add_u32 v1, s38, v1
    ds_write_b128 v1, a[0:3] offset:0
    ds_write_b128 v1, a[4:7] offset:1024
    ds_write_b128 v1, a[8:11] offset:2048
    ds_write_b128 v1, a[12:15] offset:3072
    ds_write_b128 v1, a[16:19] offset:4096
    ds_write_b128 v1, a[20:23] offset:5120
    ds_write_b128 v1, a[24:27] offset:6144
    ds_write_b128 v1, a[28:31] offset:7168
    ds_write_b128 v1, a[32:35] offset:8192
    ds_write_b128 v1, a[36:39] offset:9216
    ds_write_b128 v1, a[40:43] offset:10240
    ds_write_b128 v1, a[44:47] offset:11264
    ds_write_b128 v1, a[48:51] offset:12288
    ds_write_b128 v1, a[52:55] offset:13312
    ds_write_b128 v1, a[56:59] offset:14336
    ds_write_b128 v1, a[60:63] offset:15360
    ds_write_b128 v1, a[64:67] offset:16384
    ds_write_b128 v1, a[68:71] offset:17408
    ds_write_b128 v1, a[72:75] offset:18432
    ds_write_b128 v1, a[76:79] offset:19456
    ds_write_b128 v1, a[80:83] offset:20480
    ds_write_b128 v1, a[84:87] offset:21504
    ds_write_b128 v1, a[88:91] offset:22528
    ds_write_b128 v1, a[92:95] offset:23552
    ds_write_b128 v1, a[96:99] offset:24576
    ds_write_b128 v1, a[100:103] offset:25600
    ds_write_b128 v1, a[104:107] offset:26624
    ds_write_b128 v1, a[108:111] offset:27648
    ds_write_b128 v1, a[112:115] offset:28672
    ds_write_b128 v1, a[116:119] offset:29696
    ds_write_b128 v1, a[120:123] offset:30720
    ds_write_b128 v1, a[124:127] offset:31744
    s_waitcnt lgkmcnt(0)
    s_barrier
    v_lshlrev_b32 v1, 4, v0
    s_lshl_b32 s38, s18, 12
    v_add_u32 v1, s38, v1
    v_add_u32 v2, 0x10000, v1
    ds_read_b128 v[64:67], v1 offset:0
    ds_read_b128 v[68:71], v1 offset:1024
    ds_read_b128 v[72:75], v1 offset:2048
    ds_read_b128 v[76:79], v1 offset:3072
    ds_read_b128 v[80:83], v1 offset:32768
    ds_read_b128 v[84:87], v1 offset:33792
    ds_read_b128 v[88:91], v1 offset:34816
    ds_read_b128 v[92:95], v1 offset:35840
    ds_read_b128 v[96:99], v2 offset:0
    ds_read_b128 v[100:103], v2 offset:1024
    ds_read_b128 v[104:107], v2 offset:2048
    ds_read_b128 v[108:111], v2 offset:3072
    ds_read_b128 v[112:115], v2 offset:32768
    ds_read_b128 v[116:119], v2 offset:33792
    ds_read_b128 v[120:123], v2 offset:34816
    ds_read_b128 v[124:127], v2 offset:35840
    ds_read_b128 v[128:131], v1 offset:16384
    ds_read_b128 v[132:135], v1 offset:17408
    ds_read_b128 v[136:139], v1 offset:18432
    ds_read_b128 v[140:143], v1 offset:19456
    ds_read_b128 v[144:147], v1 offset:49152
    ds_read_b128 v[148:151], v1 offset:50176
    ds_read_b128 v[152:155], v1 offset:51200
    ds_read_b128 v[156:159], v1 offset:52224
    ds_read_b128 v[160:163], v2 offset:16384
    ds_read_b128 v[164:167], v2 offset:17408
    ds_read_b128 v[168:171], v2 offset:18432
    ds_read_b128 v[172:175], v2 offset:19456
    ds_read_b128 v[176:179], v2 offset:49152
    ds_read_b128 v[180:183], v2 offset:50176
    ds_read_b128 v[184:187], v2 offset:51200
    ds_read_b128 v[188:191], v2 offset:52224
    s_mov_b32 s20, s4
    s_and_b32 s21, s5, 0xffff
    s_mov_b32 s22, 0x200000
    s_mov_b32 s23, 0x00020000
    s_mov_b32 s24, s10
    s_and_b32 s25, s11, 0xffff
    s_mov_b32 s26, 0x200000
    s_mov_b32 s27, 0x00020000
    v_and_b32 v1, 31, v0
    v_lshrrev_b32 v2, 5, v0
    s_and_b32 s38, s18, 1
    s_lshl_b32 s38, s38, 5
    s_lshl_b32 s39, s16, 6
    s_add_u32 s38, s38, s39
    v_add_u32 v1, s38, v1
    v_lshlrev_b32 v1, 10, v1
    s_lshr_b32 s38, s18, 1
    s_lshl_b32 s38, s38, 6
    s_lshl_b32 s39, s17, 7
    s_add_u32 s38, s38, s39
    v_add_u32 v1, s38, v1
    v_lshl_add_u32 v3, v2, 3, v1
    v_lshl_add_u32 v4, v2, 4, v1
    buffer_load_dwordx2 v[192:193], v3, s[20:23], 0 offen offset:0
    buffer_load_dwordx2 v[194:195], v3, s[20:23], 0 offen offset:16
    buffer_load_dwordx2 v[196:197], v3, s[20:23], 0 offen offset:32
    buffer_load_dwordx2 v[198:199], v3, s[20:23], 0 offen offset:48
    s_waitcnt lgkmcnt(0)
    v_add_f32 v32, v64, v80
    v_add_f32 v96, v96, v112
    v_add_f32 v32, v32, v96
    v_add_f32 v33, v65, v81
    v_add_f32 v97, v97, v113
    v_add_f32 v33, v33, v97
    v_add_f32 v34, v66, v82
    v_add_f32 v98, v98, v114
    v_add_f32 v34, v34, v98
    v_add_f32 v35, v67, v83
    v_add_f32 v99, v99, v115
    v_add_f32 v35, v35, v99
    v_add_f32 v36, v68, v84
    v_add_f32 v100, v100, v116
    v_add_f32 v36, v36, v100
    v_add_f32 v37, v69, v85
    v_add_f32 v101, v101, v117
    v_add_f32 v37, v37, v101
    v_add_f32 v38, v70, v86
    v_add_f32 v102, v102, v118
    v_add_f32 v38, v38, v102
    v_add_f32 v39, v71, v87
    v_add_f32 v103, v103, v119
    v_add_f32 v39, v39, v103
    v_add_f32 v40, v72, v88
    v_add_f32 v104, v104, v120
    v_add_f32 v40, v40, v104
    v_add_f32 v41, v73, v89
    v_add_f32 v105, v105, v121
    v_add_f32 v41, v41, v105
    v_add_f32 v42, v74, v90
    v_add_f32 v106, v106, v122
    v_add_f32 v42, v42, v106
    v_add_f32 v43, v75, v91
    v_add_f32 v107, v107, v123
    v_add_f32 v43, v43, v107
    v_add_f32 v44, v76, v92
    v_add_f32 v108, v108, v124
    v_add_f32 v44, v44, v108
    v_add_f32 v45, v77, v93
    v_add_f32 v109, v109, v125
    v_add_f32 v45, v45, v109
    v_add_f32 v46, v78, v94
    v_add_f32 v110, v110, v126
    v_add_f32 v46, v46, v110
    v_add_f32 v47, v79, v95
    v_add_f32 v111, v111, v127
    v_add_f32 v47, v47, v111
    v_add_f32 v48, v128, v144
    v_add_f32 v160, v160, v176
    v_add_f32 v48, v48, v160
    v_add_f32 v49, v129, v145
    v_add_f32 v161, v161, v177
    v_add_f32 v49, v49, v161
    v_add_f32 v50, v130, v146
    v_add_f32 v162, v162, v178
    v_add_f32 v50, v50, v162
    v_add_f32 v51, v131, v147
    v_add_f32 v163, v163, v179
    v_add_f32 v51, v51, v163
    v_add_f32 v52, v132, v148
    v_add_f32 v164, v164, v180
    v_add_f32 v52, v52, v164
    v_add_f32 v53, v133, v149
    v_add_f32 v165, v165, v181
    v_add_f32 v53, v53, v165
    v_add_f32 v54, v134, v150
    v_add_f32 v166, v166, v182
    v_add_f32 v54, v54, v166
    v_add_f32 v55, v135, v151
    v_add_f32 v167, v167, v183
    v_add_f32 v55, v55, v167
    v_add_f32 v56, v136, v152
    v_add_f32 v168, v168, v184
    v_add_f32 v56, v56, v168
    v_add_f32 v57, v137, v153
    v_add_f32 v169, v169, v185
    v_add_f32 v57, v57, v169
    v_add_f32 v58, v138, v154
    v_add_f32 v170, v170, v186
    v_add_f32 v58, v58, v170
    v_add_f32 v59, v139, v155
    v_add_f32 v171, v171, v187
    v_add_f32 v59, v59, v171
    v_add_f32 v60, v140, v156
    v_add_f32 v172, v172, v188
    v_add_f32 v60, v60, v172
    v_add_f32 v61, v141, v157
    v_add_f32 v173, v173, v189
    v_add_f32 v61, v61, v173
    v_add_f32 v62, v142, v158
    v_add_f32 v174, v174, v190
    v_add_f32 v62, v62, v174
    v_add_f32 v63, v143, v159
    v_add_f32 v175, v175, v191
    v_add_f32 v63, v63, v175
    s_mov_b32 s38, 0xbfb8aa3b
    v_cvt_pk_bf16_f32 v32, v32, v32
    v_lshlrev_b32 v32, 16, v32
    v_cvt_pk_bf16_f32 v48, v48, v48
    v_lshlrev_b32 v48, 16, v48
    v_mul_f32 v80, s38, v48
    v_exp_f32 v80, v80
    v_cvt_pk_bf16_f32 v33, v33, v33
    v_lshlrev_b32 v33, 16, v33
    v_cvt_pk_bf16_f32 v49, v49, v49
    v_lshlrev_b32 v49, 16, v49
    v_mul_f32 v81, s38, v49
    v_exp_f32 v81, v81
    v_cvt_pk_bf16_f32 v34, v34, v34
    v_lshlrev_b32 v34, 16, v34
    v_cvt_pk_bf16_f32 v50, v50, v50
    v_lshlrev_b32 v50, 16, v50
    v_mul_f32 v82, s38, v50
    v_exp_f32 v82, v82
    v_cvt_pk_bf16_f32 v35, v35, v35
    v_lshlrev_b32 v35, 16, v35
    v_cvt_pk_bf16_f32 v51, v51, v51
    v_lshlrev_b32 v51, 16, v51
    v_mul_f32 v83, s38, v51
    v_exp_f32 v83, v83
    v_cvt_pk_bf16_f32 v36, v36, v36
    v_lshlrev_b32 v36, 16, v36
    v_cvt_pk_bf16_f32 v52, v52, v52
    v_lshlrev_b32 v52, 16, v52
    v_mul_f32 v84, s38, v52
    v_exp_f32 v84, v84
    v_cvt_pk_bf16_f32 v37, v37, v37
    v_lshlrev_b32 v37, 16, v37
    v_cvt_pk_bf16_f32 v53, v53, v53
    v_lshlrev_b32 v53, 16, v53
    v_mul_f32 v85, s38, v53
    v_exp_f32 v85, v85
    v_cvt_pk_bf16_f32 v38, v38, v38
    v_lshlrev_b32 v38, 16, v38
    v_cvt_pk_bf16_f32 v54, v54, v54
    v_lshlrev_b32 v54, 16, v54
    v_mul_f32 v86, s38, v54
    v_exp_f32 v86, v86
    v_cvt_pk_bf16_f32 v39, v39, v39
    v_lshlrev_b32 v39, 16, v39
    v_cvt_pk_bf16_f32 v55, v55, v55
    v_lshlrev_b32 v55, 16, v55
    v_mul_f32 v87, s38, v55
    v_exp_f32 v87, v87
    v_cvt_pk_bf16_f32 v40, v40, v40
    v_lshlrev_b32 v40, 16, v40
    v_cvt_pk_bf16_f32 v56, v56, v56
    v_lshlrev_b32 v56, 16, v56
    v_mul_f32 v88, s38, v56
    v_exp_f32 v88, v88
    v_cvt_pk_bf16_f32 v41, v41, v41
    v_lshlrev_b32 v41, 16, v41
    v_cvt_pk_bf16_f32 v57, v57, v57
    v_lshlrev_b32 v57, 16, v57
    v_mul_f32 v89, s38, v57
    v_exp_f32 v89, v89
    v_cvt_pk_bf16_f32 v42, v42, v42
    v_lshlrev_b32 v42, 16, v42
    v_cvt_pk_bf16_f32 v58, v58, v58
    v_lshlrev_b32 v58, 16, v58
    v_mul_f32 v90, s38, v58
    v_exp_f32 v90, v90
    v_cvt_pk_bf16_f32 v43, v43, v43
    v_lshlrev_b32 v43, 16, v43
    v_cvt_pk_bf16_f32 v59, v59, v59
    v_lshlrev_b32 v59, 16, v59
    v_mul_f32 v91, s38, v59
    v_exp_f32 v91, v91
    v_cvt_pk_bf16_f32 v44, v44, v44
    v_lshlrev_b32 v44, 16, v44
    v_cvt_pk_bf16_f32 v60, v60, v60
    v_lshlrev_b32 v60, 16, v60
    v_mul_f32 v92, s38, v60
    v_exp_f32 v92, v92
    v_cvt_pk_bf16_f32 v45, v45, v45
    v_lshlrev_b32 v45, 16, v45
    v_cvt_pk_bf16_f32 v61, v61, v61
    v_lshlrev_b32 v61, 16, v61
    v_mul_f32 v93, s38, v61
    v_exp_f32 v93, v93
    v_cvt_pk_bf16_f32 v46, v46, v46
    v_lshlrev_b32 v46, 16, v46
    v_cvt_pk_bf16_f32 v62, v62, v62
    v_lshlrev_b32 v62, 16, v62
    v_mul_f32 v94, s38, v62
    v_exp_f32 v94, v94
    v_cvt_pk_bf16_f32 v47, v47, v47
    v_lshlrev_b32 v47, 16, v47
    v_cvt_pk_bf16_f32 v63, v63, v63
    v_lshlrev_b32 v63, 16, v63
    v_mul_f32 v95, s38, v63
    v_exp_f32 v95, v95
    v_add_f32 v80, 1.0, v80
    v_rcp_f32 v80, v80
    v_add_f32 v81, 1.0, v81
    v_rcp_f32 v81, v81
    v_add_f32 v82, 1.0, v82
    v_rcp_f32 v82, v82
    v_add_f32 v83, 1.0, v83
    v_rcp_f32 v83, v83
    v_add_f32 v84, 1.0, v84
    v_rcp_f32 v84, v84
    v_add_f32 v85, 1.0, v85
    v_rcp_f32 v85, v85
    v_add_f32 v86, 1.0, v86
    v_rcp_f32 v86, v86
    v_add_f32 v87, 1.0, v87
    v_rcp_f32 v87, v87
    v_add_f32 v88, 1.0, v88
    v_rcp_f32 v88, v88
    v_add_f32 v89, 1.0, v89
    v_rcp_f32 v89, v89
    v_add_f32 v90, 1.0, v90
    v_rcp_f32 v90, v90
    v_add_f32 v91, 1.0, v91
    v_rcp_f32 v91, v91
    v_add_f32 v92, 1.0, v92
    v_rcp_f32 v92, v92
    v_add_f32 v93, 1.0, v93
    v_rcp_f32 v93, v93
    v_add_f32 v94, 1.0, v94
    v_rcp_f32 v94, v94
    v_add_f32 v95, 1.0, v95
    v_rcp_f32 v95, v95
    v_mul_f32 v48, v48, v80
    v_cvt_pk_bf16_f32 v48, v48, v48
    v_lshlrev_b32 v48, 16, v48
    v_mul_f32 v32, v32, v48
    v_cvt_pk_bf16_f32 v32, v32, v32
    v_lshlrev_b32 v32, 16, v32
    v_mul_f32 v49, v49, v81
    v_cvt_pk_bf16_f32 v49, v49, v49
    v_lshlrev_b32 v49, 16, v49
    v_mul_f32 v33, v33, v49
    v_cvt_pk_bf16_f32 v33, v33, v33
    v_lshlrev_b32 v33, 16, v33
    v_mul_f32 v50, v50, v82
    v_cvt_pk_bf16_f32 v50, v50, v50
    v_lshlrev_b32 v50, 16, v50
    v_mul_f32 v34, v34, v50
    v_cvt_pk_bf16_f32 v34, v34, v34
    v_lshlrev_b32 v34, 16, v34
    v_mul_f32 v51, v51, v83
    v_cvt_pk_bf16_f32 v51, v51, v51
    v_lshlrev_b32 v51, 16, v51
    v_mul_f32 v35, v35, v51
    v_cvt_pk_bf16_f32 v35, v35, v35
    v_lshlrev_b32 v35, 16, v35
    v_mul_f32 v52, v52, v84
    v_cvt_pk_bf16_f32 v52, v52, v52
    v_lshlrev_b32 v52, 16, v52
    v_mul_f32 v36, v36, v52
    v_cvt_pk_bf16_f32 v36, v36, v36
    v_lshlrev_b32 v36, 16, v36
    v_mul_f32 v53, v53, v85
    v_cvt_pk_bf16_f32 v53, v53, v53
    v_lshlrev_b32 v53, 16, v53
    v_mul_f32 v37, v37, v53
    v_cvt_pk_bf16_f32 v37, v37, v37
    v_lshlrev_b32 v37, 16, v37
    v_mul_f32 v54, v54, v86
    v_cvt_pk_bf16_f32 v54, v54, v54
    v_lshlrev_b32 v54, 16, v54
    v_mul_f32 v38, v38, v54
    v_cvt_pk_bf16_f32 v38, v38, v38
    v_lshlrev_b32 v38, 16, v38
    v_mul_f32 v55, v55, v87
    v_cvt_pk_bf16_f32 v55, v55, v55
    v_lshlrev_b32 v55, 16, v55
    v_mul_f32 v39, v39, v55
    v_cvt_pk_bf16_f32 v39, v39, v39
    v_lshlrev_b32 v39, 16, v39
    v_mul_f32 v56, v56, v88
    v_cvt_pk_bf16_f32 v56, v56, v56
    v_lshlrev_b32 v56, 16, v56
    v_mul_f32 v40, v40, v56
    v_cvt_pk_bf16_f32 v40, v40, v40
    v_lshlrev_b32 v40, 16, v40
    v_mul_f32 v57, v57, v89
    v_cvt_pk_bf16_f32 v57, v57, v57
    v_lshlrev_b32 v57, 16, v57
    v_mul_f32 v41, v41, v57
    v_cvt_pk_bf16_f32 v41, v41, v41
    v_lshlrev_b32 v41, 16, v41
    v_mul_f32 v58, v58, v90
    v_cvt_pk_bf16_f32 v58, v58, v58
    v_lshlrev_b32 v58, 16, v58
    v_mul_f32 v42, v42, v58
    v_cvt_pk_bf16_f32 v42, v42, v42
    v_lshlrev_b32 v42, 16, v42
    v_mul_f32 v59, v59, v91
    v_cvt_pk_bf16_f32 v59, v59, v59
    v_lshlrev_b32 v59, 16, v59
    v_mul_f32 v43, v43, v59
    v_cvt_pk_bf16_f32 v43, v43, v43
    v_lshlrev_b32 v43, 16, v43
    v_mul_f32 v60, v60, v92
    v_cvt_pk_bf16_f32 v60, v60, v60
    v_lshlrev_b32 v60, 16, v60
    v_mul_f32 v44, v44, v60
    v_cvt_pk_bf16_f32 v44, v44, v44
    v_lshlrev_b32 v44, 16, v44
    v_mul_f32 v61, v61, v93
    v_cvt_pk_bf16_f32 v61, v61, v61
    v_lshlrev_b32 v61, 16, v61
    v_mul_f32 v45, v45, v61
    v_cvt_pk_bf16_f32 v45, v45, v45
    v_lshlrev_b32 v45, 16, v45
    v_mul_f32 v62, v62, v94
    v_cvt_pk_bf16_f32 v62, v62, v62
    v_lshlrev_b32 v62, 16, v62
    v_mul_f32 v46, v46, v62
    v_cvt_pk_bf16_f32 v46, v46, v46
    v_lshlrev_b32 v46, 16, v46
    v_mul_f32 v63, v63, v95
    v_cvt_pk_bf16_f32 v63, v63, v63
    v_lshlrev_b32 v63, 16, v63
    v_mul_f32 v47, v47, v63
    v_cvt_pk_bf16_f32 v47, v47, v47
    v_lshlrev_b32 v47, 16, v47
    s_waitcnt vmcnt(0)
    v_lshlrev_b32 v96, 16, v192
    v_and_b32 v97, 0xffff0000, v192
    v_add_f32 v96, v96, v32
    v_add_f32 v97, v97, v33
    v_cvt_pk_bf16_f32 v100, v96, v97
    v_lshlrev_b32 v96, 16, v193
    v_and_b32 v97, 0xffff0000, v193
    v_add_f32 v96, v96, v34
    v_add_f32 v97, v97, v35
    v_cvt_pk_bf16_f32 v101, v96, v97
    v_lshlrev_b32 v96, 16, v194
    v_and_b32 v97, 0xffff0000, v194
    v_add_f32 v96, v96, v36
    v_add_f32 v97, v97, v37
    v_cvt_pk_bf16_f32 v102, v96, v97
    v_lshlrev_b32 v96, 16, v195
    v_and_b32 v97, 0xffff0000, v195
    v_add_f32 v96, v96, v38
    v_add_f32 v97, v97, v39
    v_cvt_pk_bf16_f32 v103, v96, v97
    v_lshlrev_b32 v96, 16, v196
    v_and_b32 v97, 0xffff0000, v196
    v_add_f32 v96, v96, v40
    v_add_f32 v97, v97, v41
    v_cvt_pk_bf16_f32 v104, v96, v97
    v_lshlrev_b32 v96, 16, v197
    v_and_b32 v97, 0xffff0000, v197
    v_add_f32 v96, v96, v42
    v_add_f32 v97, v97, v43
    v_cvt_pk_bf16_f32 v105, v96, v97
    v_lshlrev_b32 v96, 16, v198
    v_and_b32 v97, 0xffff0000, v198
    v_add_f32 v96, v96, v44
    v_add_f32 v97, v97, v45
    v_cvt_pk_bf16_f32 v106, v96, v97
    v_lshlrev_b32 v96, 16, v199
    v_and_b32 v97, 0xffff0000, v199
    v_add_f32 v96, v96, v46
    v_add_f32 v97, v97, v47
    v_cvt_pk_bf16_f32 v107, v96, v97
    s_nop 1
    v_permlane32_swap_b32 v100, v102
    v_permlane32_swap_b32 v101, v103
    buffer_store_dwordx4 v[100:103], v4, s[24:27], 0 offen offset:0
    v_permlane32_swap_b32 v104, v106
    v_permlane32_swap_b32 v105, v107
    buffer_store_dwordx4 v[104:107], v4, s[24:27], 0 offen offset:32
k3_fin:
k3_done:
    s_endpgm
.section .rodata,"a"
.p2align 6
.amdhsa_kernel ln_kernel
  .amdhsa_next_free_vgpr 24
  .amdhsa_next_free_sgpr 102
  .amdhsa_accum_offset 24
  .amdhsa_group_segment_fixed_size 0
  .amdhsa_kernarg_size 96
  .amdhsa_user_sgpr_count 2
  .amdhsa_user_sgpr_kernarg_segment_ptr 1
  .amdhsa_system_sgpr_workgroup_id_x 1
.end_amdhsa_kernel
.p2align 6
.amdhsa_kernel proj_kernel
  .amdhsa_next_free_vgpr 240
  .amdhsa_next_free_sgpr 102
  .amdhsa_accum_offset 112
  .amdhsa_group_segment_fixed_size 0
  .amdhsa_kernarg_size 96
  .amdhsa_user_sgpr_count 2
  .amdhsa_user_sgpr_kernarg_segment_ptr 1
  .amdhsa_system_sgpr_workgroup_id_x 1
.end_amdhsa_kernel
.p2align 6
.amdhsa_kernel attn_kernel
  .amdhsa_next_free_vgpr 512
  .amdhsa_next_free_sgpr 102
  .amdhsa_accum_offset 256
  .amdhsa_group_segment_fixed_size 0
  .amdhsa_kernarg_size 96
  .amdhsa_user_sgpr_count 2
  .amdhsa_user_sgpr_kernarg_segment_ptr 1
  .amdhsa_system_sgpr_workgroup_id_x 1
.end_amdhsa_kernel
.p2align 6
.amdhsa_kernel out_kernel
  .amdhsa_next_free_vgpr 348
  .amdhsa_next_free_sgpr 102
  .amdhsa_accum_offset 220
  .amdhsa_group_segment_fixed_size 0
  .amdhsa_kernarg_size 96
  .amdhsa_user_sgpr_count 2
  .amdhsa_user_sgpr_kernarg_segment_ptr 1
  .amdhsa_system_sgpr_workgroup_id_x 1
.end_amdhsa_kernel
```
